```python
import torch

def _softmax(x, axis=-1):
    return torch.softmax(x, dim=axis)
def _gelu(x):
    return torch.nn.functional.gelu(x, approximate="tanh")
def _silu(x):
    return torch.nn.functional.silu(x)
def _sigmoid(x):
    return torch.sigmoid(x)
def _layernorm(x, axis=-1, eps=1e-5):
    m = x.mean(dim=axis, keepdim=True)
    v = x.var(dim=axis, keepdim=True, unbiased=False)
    return (x - m) / torch.sqrt(v + eps)
def _scatter_add(tgt, idx, src, axis=0):
    return tgt.clone().index_add_(axis, idx, src)
def _segment_sum(src, seg, n):
    out = torch.zeros((n,) + src.shape[1:], dtype=src.dtype)
    return out.index_add_(0, seg, src)
def _pad(x, pw):
    flat = tuple(v for pair in reversed(pw) for v in pair)
    return torch.nn.functional.pad(x, flat)

kernel_name = 'standalone__qk_norm__prompt'

def setup_inputs():

    _w = (lambda a: (lambda t: t.to(torch.bfloat16) if t.is_floating_point() else t)(torch.as_tensor(a)))
    B, H, S, D = 2, 16, 2048, 448
    Dh = D // H
    return {
        "q": _w((lambda *s: torch.randn(*s, dtype=torch.bfloat16) * 0.05)(B, H, S, Dh)),
        "k": _w((lambda *s: torch.randn(*s, dtype=torch.bfloat16) * 0.05)(B, H, S, Dh)),
        "v": _w((lambda *s: torch.randn(*s, dtype=torch.bfloat16) * 1.6)(B, H, S, Dh)),
        "t": _w(torch.abs((lambda *s: torch.randn(*s, dtype=torch.bfloat16) * 1.6)(H)) + 1.0),
    }

def reference(q, k, v, t):
    eps = 1e-6
    qn = q / (torch.sqrt((q * q).sum(axis=-1, keepdims=True)) + eps)
    kn = k / (torch.sqrt((k * k).sum(axis=-1, keepdims=True)) + eps)
    logits = torch.einsum('bhqd,bhkd->bhqk', qn, kn) * t[None, :, None, None]
    attn = _softmax(logits, axis=-1)
    return torch.einsum('bhqk,bhkd->bhqd', attn, v)
```

```asm
; @launch grid=(256,1,1) block=(512,1,1) lds=114944
.amdgcn_target "amdgcn-amd-amdhsa--gfx950"
.text
.p2align 12
.fill 832, 4, 0xbf810000
.globl standalone__qk_norm__prompt_kernel
.p2align 8
.type standalone__qk_norm__prompt_kernel,@function
standalone__qk_norm__prompt_kernel:
    s_load_dwordx2 s[20:21], s[0:1], 8
    s_cmp_ge_u32 s2, 256
    s_cbranch_scc1 L_end
    s_load_dwordx2 s[16:17], s[0:1], 0
    s_load_dwordx2 s[24:25], s[0:1], 16
    s_load_dwordx2 s[10:11], s[0:1], 24
    s_load_dwordx2 s[28:29], s[0:1], 32
    v_lshrrev_b32 v1, 6, v0
    v_and_b32 v0, 63, v0
    v_readfirstlane_b32 s3, v1
    s_setprio 3
    s_and_b32 s32, s2, 7
    s_lshl_b32 s32, s32, 2
    s_bfe_u32 s33, s2, 0x20003
    s_add_u32 s32, s32, s33
    s_lshr_b32 s33, s2, 5
    s_mul_i32 s44, s3, 13312
    v_lshlrev_b32 v1, 4, v0
    v_mov_b32 v8, 0
    v_add_u32 v7, s44, v1
    ds_write_b32 v7, v8 offset:12288
    s_mul_i32 s34, s32, 114688
    s_mul_i32 s35, s33, 14336
    s_add_u32 s35, s35, s34
    s_mul_i32 s36, s3, 1792
    s_add_u32 s36, s36, s35
    s_xor_b32 s38, s3, 4
    s_mul_i32 s38, s38, 13312
    s_mul_i32 s37, s3, 14336
    s_add_u32 s37, s37, s34
    s_add_u32 s92, s37, 0
    s_add_u32 s93, s37, 1792
    s_and_b32 s15, s32, 14
    s_lshl_b32 s15, s15, 1
    v_and_b32 v16, 31, v0
    v_lshrrev_b32 v17, 5, v0
    v_mul_u32_u24 v16, 56, v16
    v_mad_u32_u24 v2, v17, 28, v16
    v_cmp_gt_u32 vcc, 48, v0
    v_bfrev_b32 v18, 2
    s_mov_b32 s18, 3670016
    s_mov_b32 s19, 0x00020000
    v_cndmask_b32 v3, v18, v1, vcc
    s_mov_b32 s22, s18
    s_mov_b32 s23, 0x00020000
    s_mov_b32 s26, s18
    s_mov_b32 s27, 0x00020000
    s_mov_b32 s30, s18
    s_mov_b32 s31, 0x00020000
    v_bfe_u32 v18, v0, 2, 2
    v_mul_u32_u24 v18, 56, v18
    v_mul_u32_u24 v19, 448, v17
    v_add3_u32 v18, v18, v19, s44
    v_and_b32 v19, 1, v0
    v_bfe_u32 v20, v0, 1, 1
    v_bfe_u32 v21, v0, 4, 1
    v_lshl_or_b32 v20, v21, 1, v20
    v_lshl_or_b32 v19, v19, 2, v20
    v_lshl_add_u32 v18, v19, 3, v18
    v_cmp_eq_u32 vcc, 7, v19
    v_mov_b32 v20, 106496
    v_mov_b32 v5, 1
    v_cndmask_b32 v4, v18, v20, vcc
    v_and_b32 v18, 5, v0
    v_mul_u32_u24 v18, 224, v18
    v_bfe_u32 v19, v0, 1, 1
    v_lshl_add_u32 v18, v19, 11, v18
    v_and_b32 v19, 8, v0
    v_lshl_add_u32 v18, v19, 9, v18
    v_add_u32 v18, v18, v20
    v_mov_b32 v22, 0x3f80
    v_mov_b32 v23, 0x0
    ds_write_b64 v18, v[22:23]
    v_mov_b32 v6, 0xdddddddd
    v_and_b32 v18, 1, v0
    v_lshlrev_b32 v18, 4, v18
    v_mov_b32 v19, 0x3f80
    v_lshlrev_b32 v18, v18, v19
    v_and_b32 v20, 2, v0
    v_cmp_eq_u32 vcc, 0, v20
    s_mov_b32 s58, 1
    s_and_b32 s59, s3, 4
    s_lshl_b32 s59, s59, 2
    s_mov_b32 s57, 0x100000
    v_cndmask_b32 v12, 0, v18, vcc
    v_cndmask_b32 v13, v18, 0, vcc
    s_cmp_lt_u32 s3, 4
    s_waitcnt lgkmcnt(0)
    buffer_load_dwordx4 v[32:35], v2, s[20:23], s92 offen
    s_load_dword s14, s[10:11], s15
    buffer_load_dwordx3 v[36:38], v2, s[20:23], s92 offen offset:16
    buffer_load_dwordx4 v[40:43], v2, s[20:23], s93 offen
    buffer_load_dwordx3 v[44:46], v2, s[20:23], s93 offen offset:16
    s_barrier
    buffer_load_dwordx4 v[160:163], v2, s[16:19], s36 offen
    buffer_load_dwordx3 v[164:166], v2, s[16:19], s36 offen offset:16
    s_add_u32 m0, s44, 0
    s_nop 0
    buffer_load_dwordx4 v1, s[24:27], s92 offen  lds
    buffer_load_dwordx4 v3, s[24:27], s92 offen offset:1024  lds
    s_add_u32 m0, s44, 2048
    s_nop 0
    buffer_load_dwordx4 v1, s[24:27], s93 offen  lds
    buffer_load_dwordx4 v3, s[24:27], s93 offen offset:1024  lds
L_mark:
    s_add_u32 s54, s3, 1
    s_and_b32 s54, s54, 3
    s_and_b32 s55, s3, 4
    s_or_b32 s54, s54, s55
    s_mul_i32 s50, s54, 832
    s_add_u32 s54, s3, 2
    s_and_b32 s54, s54, 3
    s_and_b32 s55, s3, 4
    s_or_b32 s54, s54, s55
    s_mul_i32 s51, s54, 832
    s_add_u32 s54, s3, 3
    s_and_b32 s54, s54, 3
    s_and_b32 s55, s3, 4
    s_or_b32 s54, s54, s55
    s_mul_i32 s52, s54, 832
    s_xor_b32 s54, s54, 4
    s_mul_i32 s53, s54, 832
    s_pack_ll_b32_b16 s48, s50, s51
    s_pack_ll_b32_b16 s49, s52, s53
    v_mov_b32 v39, v19
    v_mov_b32 v47, v19
    v_mov_b32 v55, v19
    v_mov_b32 v63, v19
    v_mov_b32 v71, v19
    v_mov_b32 v79, v19
    v_mov_b32 v87, v19
    v_mov_b32 v95, v19
    v_mov_b64 v[176:177], 0
    v_mov_b64 v[178:179], 0
    v_mov_b64 v[180:181], 0
    v_mov_b64 v[182:183], 0
    v_mov_b64 v[184:185], 0
    v_mov_b64 v[186:187], 0
    v_mov_b64 v[188:189], 0
    v_mov_b64 v[190:191], 0
    v_mov_b64 v[192:193], 0
    v_mov_b64 v[194:195], 0
    v_mov_b64 v[196:197], 0
    v_mov_b64 v[198:199], 0
    v_mov_b64 v[200:201], 0
    v_mov_b64 v[202:203], 0
    v_mov_b64 v[204:205], 0
    v_mov_b64 v[206:207], 0
    s_add_u32 s94, s37, 3584
    s_add_u32 s95, s37, 5376
    s_add_u32 s96, s37, 7168
    s_add_u32 s97, s37, 8960
    s_add_u32 s98, s37, 10752
    s_add_u32 s99, s37, 12544
    s_waitcnt lgkmcnt(0)
    s_lshl_b32 s45, s14, 16
    s_and_b32 s46, s14, 0xffff0000
    s_and_b32 s47, s32, 1
    s_cselect_b32 s45, s46, s45
    v_mov_b32 v24, 0x3fb8aa3b
    v_mul_f32 v11, s45, v24
    s_and_b32 s46, s45, 0x7fffffff
    s_cmp_gt_u32 s46, 0x41800000
    s_cbranch_scc1 L_slow
    v_mov_b32 v167, 0xc1b2
    s_waitcnt vmcnt(6)
    v_dot2_f32_bf16 v14, v32, v32, 0
    v_dot2_f32_bf16 v15, v40, v40, 0
    v_dot2_f32_bf16 v8, v33, v33, 0
    v_dot2_f32_bf16 v9, v41, v41, 0
    v_dot2_f32_bf16 v14, v34, v34, v14
    v_dot2_f32_bf16 v15, v42, v42, v15
    v_dot2_f32_bf16 v8, v35, v35, v8
    v_dot2_f32_bf16 v9, v43, v43, v9
    v_dot2_f32_bf16 v14, v36, v36, v14
    v_dot2_f32_bf16 v15, v44, v44, v15
    v_dot2_f32_bf16 v8, v37, v37, v8
    v_dot2_f32_bf16 v9, v45, v45, v9
    v_dot2_f32_bf16 v14, v38, v38, v14
    v_dot2_f32_bf16 v15, v46, v46, v15
    v_mfma_f32_4x4x4_16b_bf16 v[16:19], v[12:13], v[32:33], 0
    v_mfma_f32_4x4x4_16b_bf16 v[20:23], v[12:13], v[34:35], 0
    v_add_f32 v14, v14, v8
    v_add_f32 v15, v15, v9
    v_mfma_f32_4x4x4_16b_bf16 v[24:27], v[12:13], v[36:37], 0
    v_mfma_f32_4x4x4_16b_bf16 v[28:31], v[12:13], v[38:39], 0
    v_permlane32_swap_b32 v14, v15
    v_add_f32 v14, v14, v15
    v_sqrt_f32 v14, v14
    v_mfma_f32_4x4x4_16b_bf16 v[208:211], v[12:13], v[40:41], 0
    v_add_f32 v14, 0x358637bd, v14
    v_rcp_f32 v14, v14
    v_mfma_f32_4x4x4_16b_bf16 v[212:215], v[12:13], v[42:43], 0
    v_mov_b32 v15, v14
    v_mfma_f32_4x4x4_16b_bf16 v[216:219], v[12:13], v[44:45], 0
    v_mfma_f32_4x4x4_16b_bf16 v[220:223], v[12:13], v[46:47], 0
    v_permlane32_swap_b32 v14, v15
    v_pk_mul_f32 v[16:17], v[16:17], v[14:15] op_sel_hi:[1,0]
    v_pk_mul_f32 v[18:19], v[18:19], v[14:15] op_sel_hi:[1,0]
    v_pk_mul_f32 v[20:21], v[20:21], v[14:15] op_sel_hi:[1,0]
    v_pk_mul_f32 v[22:23], v[22:23], v[14:15] op_sel_hi:[1,0]
    v_pk_mul_f32 v[24:25], v[24:25], v[14:15] op_sel_hi:[1,0]
    v_pk_mul_f32 v[26:27], v[26:27], v[14:15] op_sel_hi:[1,0]
    v_pk_mul_f32 v[28:29], v[28:29], v[14:15] op_sel_hi:[1,0]
    v_pk_mul_f32 v[208:209], v[208:209], v[14:15] op_sel:[0,1]
    v_pk_mul_f32 v[210:211], v[210:211], v[14:15] op_sel:[0,1]
    v_pk_mul_f32 v[212:213], v[212:213], v[14:15] op_sel:[0,1]
    v_pk_mul_f32 v[214:215], v[214:215], v[14:15] op_sel:[0,1]
    v_pk_mul_f32 v[216:217], v[216:217], v[14:15] op_sel:[0,1]
    v_pk_mul_f32 v[218:219], v[218:219], v[14:15] op_sel:[0,1]
    v_pk_mul_f32 v[220:221], v[220:221], v[14:15] op_sel:[0,1]
    v_cvt_pk_bf16_f32 v32, v16, v17
    v_cvt_pk_bf16_f32 v33, v18, v19
    v_cvt_pk_bf16_f32 v34, v20, v21
    v_cvt_pk_bf16_f32 v35, v22, v23
    v_cvt_pk_bf16_f32 v36, v24, v25
    v_cvt_pk_bf16_f32 v37, v26, v27
    v_cvt_pk_bf16_f32 v38, v28, v29
    v_cvt_pk_bf16_f32 v40, v208, v209
    v_cvt_pk_bf16_f32 v41, v210, v211
    v_cvt_pk_bf16_f32 v42, v212, v213
    v_cvt_pk_bf16_f32 v43, v214, v215
    v_cvt_pk_bf16_f32 v44, v216, v217
    v_cvt_pk_bf16_f32 v45, v218, v219
    v_cvt_pk_bf16_f32 v46, v220, v221
    s_waitcnt vmcnt(4)
    v_dot2_f32_bf16 v14, v160, v160, 0
    v_dot2_f32_bf16 v8, v161, v161, 0
    v_dot2_f32_bf16 v9, v162, v162, 0
    v_dot2_f32_bf16 v14, v163, v163, v14
    v_dot2_f32_bf16 v8, v164, v164, v8
    v_dot2_f32_bf16 v9, v165, v165, v9
    v_dot2_f32_bf16 v14, v166, v166, v14
    v_mfma_f32_4x4x4_16b_bf16 v[16:19], v[12:13], v[160:161], 0
    v_mfma_f32_4x4x4_16b_bf16 v[20:23], v[12:13], v[162:163], 0
    v_add_f32 v8, v8, v9
    v_add_f32 v14, v14, v8
    v_mov_b32 v15, v14
    v_mfma_f32_4x4x4_16b_bf16 v[24:27], v[12:13], v[164:165], 0
    v_mfma_f32_4x4x4_16b_bf16 v[28:31], v[12:13], v[166:167], 0
    v_permlane32_swap_b32 v14, v15
    v_add_f32 v14, v14, v15
    v_sqrt_f32 v14, v14
    s_nop 0
    v_add_f32 v14, 0x358637bd, v14
    v_rcp_f32 v14, v14
    s_nop 0
    v_mul_f32 v14, v11, v14
    v_pk_mul_f32 v[16:17], v[16:17], v[14:15] op_sel_hi:[1,0]
    v_pk_mul_f32 v[18:19], v[18:19], v[14:15] op_sel_hi:[1,0]
    v_pk_mul_f32 v[20:21], v[20:21], v[14:15] op_sel_hi:[1,0]
    v_pk_mul_f32 v[22:23], v[22:23], v[14:15] op_sel_hi:[1,0]
    v_pk_mul_f32 v[24:25], v[24:25], v[14:15] op_sel_hi:[1,0]
    v_pk_mul_f32 v[26:27], v[26:27], v[14:15] op_sel_hi:[1,0]
    v_pk_mul_f32 v[28:29], v[28:29], v[14:15] op_sel_hi:[1,0]
    v_cvt_pk_bf16_f32 v160, v16, v17
    v_cvt_pk_bf16_f32 v161, v18, v19
    v_cvt_pk_bf16_f32 v162, v20, v21
    v_cvt_pk_bf16_f32 v163, v22, v23
    v_cvt_pk_bf16_f32 v164, v24, v25
    v_cvt_pk_bf16_f32 v165, v26, v27
    v_cvt_pk_bf16_f32 v166, v28, v29
    v_add_u32 v9, s38, v1
    s_nop 0
    v_mfma_f32_32x32x16_bf16 v[208:223], v[36:39], v[164:167], 0
    v_mfma_f32_32x32x16_bf16 v[208:223], v[32:35], v[160:163], v[208:223]
    s_setprio 2
    ds_write_b128 v9, v[160:163] offset:10240
    ds_write_b128 v9, v[164:167] offset:11264
    ds_add_u32 v9, v5 offset:12288
    buffer_load_dwordx4 v[48:51], v2, s[20:23], s94 offen
    buffer_load_dwordx3 v[52:54], v2, s[20:23], s94 offen offset:16
    s_waitcnt vmcnt(4)
    ds_read_b64_tr_b16 v[96:97], v4 offset:0
    ds_read_b64_tr_b16 v[98:99], v4 offset:224
    ds_read_b64_tr_b16 v[100:101], v4 offset:896
    ds_read_b64_tr_b16 v[102:103], v4 offset:1120
    s_waitcnt vmcnt(2)
    ds_read_b64_tr_b16 v[104:105], v4 offset:2048
    ds_read_b64_tr_b16 v[106:107], v4 offset:2272
    ds_read_b64_tr_b16 v[108:109], v4 offset:2944
    ds_read_b64_tr_b16 v[110:111], v4 offset:3168
    v_mfma_f32_32x32x16_bf16 v[224:239], v[44:47], v[164:167], 0
    v_exp_f32 v240, v208
    v_exp_f32 v241, v209
    v_exp_f32 v242, v210
    v_exp_f32 v243, v211
    v_mfma_f32_32x32x16_bf16 v[224:239], v[40:43], v[160:163], v[224:239]
    v_exp_f32 v244, v212
    v_exp_f32 v245, v213
    v_exp_f32 v246, v214
    v_exp_f32 v247, v215
    v_exp_f32 v248, v216
    v_exp_f32 v249, v217
    v_exp_f32 v250, v218
    v_exp_f32 v251, v219
    s_waitcnt lgkmcnt(0)
    v_smfmac_f32_32x32x32_bf16 v[176:191], v[96:99], v[240:247], v6
    v_exp_f32 v252, v220
    v_exp_f32 v253, v221
    v_exp_f32 v254, v222
    v_exp_f32 v255, v223
    v_exp_f32 v240, v224
    v_exp_f32 v241, v225
    v_exp_f32 v242, v226
    v_exp_f32 v243, v227
    buffer_load_dwordx4 v[56:59], v2, s[20:23], s95 offen
    buffer_load_dwordx3 v[60:62], v2, s[20:23], s95 offen offset:16
    s_add_u32 m0, s44, 4096
    s_nop 0
    buffer_load_dwordx4 v1, s[24:27], s94 offen  lds
    buffer_load_dwordx4 v3, s[24:27], s94 offen offset:1024  lds
    v_exp_f32 v244, v228
    v_exp_f32 v245, v229
    v_exp_f32 v246, v230
    v_exp_f32 v247, v231
    v_smfmac_f32_32x32x32_bf16 v[176:191], v[100:103], v[248:255], v6
    v_exp_f32 v248, v232
    v_exp_f32 v249, v233
    v_exp_f32 v250, v234
    v_exp_f32 v251, v235
    ds_read_b32 v9, v7 offset:12288
    ds_read_b128 v[168:171], v7 offset:10240
    ds_read_b128 v[172:175], v7 offset:11264
    v_smfmac_f32_32x32x32_bf16 v[176:191], v[104:107], v[240:247], v6
    v_exp_f32 v252, v236
    v_exp_f32 v253, v237
    s_waitcnt lgkmcnt(0)
    v_cmp_le_u32 vcc, s58, v9
    v_exp_f32 v254, v238
    v_exp_f32 v255, v239
    s_cbranch_vccnz L_okQ
L_redoQ:
    s_sub_u32 s57, s57, 1
    s_cbranch_scc1 L_end
    ds_read_b32 v9, v7 offset:12288
    ds_read_b128 v[168:171], v7 offset:10240
    ds_read_b128 v[172:175], v7 offset:11264
    s_waitcnt lgkmcnt(0)
    v_cmp_le_u32 vcc, s58, v9
    s_nop 4
    s_cbranch_vccz L_redoQ
L_okQ:
    v_mfma_f32_32x32x16_bf16 v[208:223], v[36:39], v[172:175], 0
    v_mfma_f32_32x32x16_bf16 v[208:223], v[32:35], v[168:171], v[208:223]
    v_mfma_f32_32x32x16_bf16 v[224:239], v[44:47], v[172:175], 0
    s_nop 10
    v_exp_f32 v240, v208
    v_exp_f32 v241, v209
    v_exp_f32 v242, v210
    v_exp_f32 v243, v211
    buffer_load_dwordx4 v[64:67], v2, s[20:23], s96 offen
    buffer_load_dwordx3 v[68:70], v2, s[20:23], s96 offen offset:16
    s_add_u32 m0, s44, 6144
    s_nop 0
    buffer_load_dwordx4 v1, s[24:27], s95 offen  lds
    buffer_load_dwordx4 v3, s[24:27], s95 offen offset:1024  lds
    v_mfma_f32_32x32x16_bf16 v[224:239], v[40:43], v[168:171], v[224:239]
    v_exp_f32 v244, v212
    v_exp_f32 v245, v213
    v_exp_f32 v246, v214
    v_exp_f32 v247, v215
    v_smfmac_f32_32x32x32_bf16 v[176:191], v[108:111], v[248:255], v6
    v_exp_f32 v248, v216
    v_exp_f32 v249, v217
    v_exp_f32 v250, v218
    v_exp_f32 v251, v219
    s_waitcnt vmcnt(6)
    s_setprio 3
    v_smfmac_f32_32x32x32_bf16 v[192:207], v[96:99], v[240:247], v6
    v_exp_f32 v252, v220
    v_exp_f32 v253, v221
    v_exp_f32 v254, v222
    v_exp_f32 v255, v223
    v_dot2_f32_bf16 v14, v48, v48, 0
    v_dot2_f32_bf16 v15, v56, v56, 0
    v_dot2_f32_bf16 v8, v49, v49, 0
    v_dot2_f32_bf16 v9, v57, v57, 0
    v_dot2_f32_bf16 v14, v50, v50, v14
    v_dot2_f32_bf16 v15, v58, v58, v15
    v_dot2_f32_bf16 v8, v51, v51, v8
    v_dot2_f32_bf16 v9, v59, v59, v9
    v_dot2_f32_bf16 v14, v52, v52, v14
    v_dot2_f32_bf16 v15, v60, v60, v15
    v_dot2_f32_bf16 v8, v53, v53, v8
    v_dot2_f32_bf16 v9, v61, v61, v9
    v_dot2_f32_bf16 v14, v54, v54, v14
    v_dot2_f32_bf16 v15, v62, v62, v15
    v_mfma_f32_4x4x4_16b_bf16 v[208:211], v[12:13], v[48:49], 0
    v_exp_f32 v240, v224
    v_add_f32 v14, v14, v8
    v_add_f32 v15, v15, v9
    v_mfma_f32_4x4x4_16b_bf16 v[212:215], v[12:13], v[50:51], 0
    v_exp_f32 v241, v225
    v_permlane32_swap_b32 v14, v15
    v_mfma_f32_4x4x4_16b_bf16 v[216:219], v[12:13], v[52:53], 0
    v_add_f32 v14, v14, v15
    v_mfma_f32_4x4x4_16b_bf16 v[220:223], v[12:13], v[54:55], 0
    v_sqrt_f32 v14, v14
    v_mfma_f32_4x4x4_16b_bf16 v[16:19], v[12:13], v[56:57], 0
    v_exp_f32 v242, v226
    v_add_f32 v14, 0x358637bd, v14
    v_mfma_f32_4x4x4_16b_bf16 v[20:23], v[12:13], v[58:59], 0
    v_rcp_f32 v14, v14
    v_mfma_f32_4x4x4_16b_bf16 v[24:27], v[12:13], v[60:61], 0
    v_exp_f32 v243, v227
    v_mov_b32 v15, v14
    v_mfma_f32_4x4x4_16b_bf16 v[28:31], v[12:13], v[62:63], 0
    v_exp_f32 v244, v228
    v_permlane32_swap_b32 v14, v15
    v_exp_f32 v245, v229
    v_exp_f32 v246, v230
    v_exp_f32 v247, v231
    v_pk_mul_f32 v[208:209], v[208:209], v[14:15] op_sel_hi:[1,0]
    v_pk_mul_f32 v[210:211], v[210:211], v[14:15] op_sel_hi:[1,0]
    v_pk_mul_f32 v[212:213], v[212:213], v[14:15] op_sel_hi:[1,0]
    v_pk_mul_f32 v[214:215], v[214:215], v[14:15] op_sel_hi:[1,0]
    v_pk_mul_f32 v[216:217], v[216:217], v[14:15] op_sel_hi:[1,0]
    v_pk_mul_f32 v[218:219], v[218:219], v[14:15] op_sel_hi:[1,0]
    v_pk_mul_f32 v[220:221], v[220:221], v[14:15] op_sel_hi:[1,0]
    v_pk_mul_f32 v[16:17], v[16:17], v[14:15] op_sel:[0,1]
    v_pk_mul_f32 v[18:19], v[18:19], v[14:15] op_sel:[0,1]
    v_pk_mul_f32 v[20:21], v[20:21], v[14:15] op_sel:[0,1]
    v_pk_mul_f32 v[22:23], v[22:23], v[14:15] op_sel:[0,1]
    v_pk_mul_f32 v[24:25], v[24:25], v[14:15] op_sel:[0,1]
    v_pk_mul_f32 v[26:27], v[26:27], v[14:15] op_sel:[0,1]
    v_pk_mul_f32 v[28:29], v[28:29], v[14:15] op_sel:[0,1]
    s_setprio 2
    v_smfmac_f32_32x32x32_bf16 v[192:207], v[100:103], v[248:255], v6
    v_cvt_pk_bf16_f32 v52, v216, v217
    v_cvt_pk_bf16_f32 v53, v218, v219
    v_cvt_pk_bf16_f32 v54, v220, v221
    v_cvt_pk_bf16_f32 v48, v208, v209
    v_cvt_pk_bf16_f32 v49, v210, v211
    v_cvt_pk_bf16_f32 v50, v212, v213
    v_cvt_pk_bf16_f32 v51, v214, v215
    s_waitcnt vmcnt(0)
    ds_read_b64_tr_b16 v[112:113], v4 offset:4096
    ds_read_b64_tr_b16 v[114:115], v4 offset:4320
    ds_read_b64_tr_b16 v[116:117], v4 offset:4992
    ds_read_b64_tr_b16 v[118:119], v4 offset:5216
    ds_read_b64_tr_b16 v[120:121], v4 offset:6144
    ds_read_b64_tr_b16 v[122:123], v4 offset:6368
    ds_read_b64_tr_b16 v[124:125], v4 offset:7040
    ds_read_b64_tr_b16 v[126:127], v4 offset:7264
    buffer_load_dwordx4 v[72:75], v2, s[20:23], s97 offen
    buffer_load_dwordx3 v[76:78], v2, s[20:23], s97 offen offset:16
    v_mfma_f32_32x32x16_bf16 v[208:223], v[52:55], v[164:167], 0
    v_cvt_pk_bf16_f32 v56, v16, v17
    v_cvt_pk_bf16_f32 v57, v18, v19
    v_cvt_pk_bf16_f32 v58, v20, v21
    v_exp_f32 v248, v232
    v_exp_f32 v249, v233
    v_mfma_f32_32x32x16_bf16 v[208:223], v[48:51], v[160:163], v[208:223]
    v_cvt_pk_bf16_f32 v59, v22, v23
    v_cvt_pk_bf16_f32 v60, v24, v25
    v_cvt_pk_bf16_f32 v61, v26, v27
    v_cvt_pk_bf16_f32 v62, v28, v29
    v_exp_f32 v250, v234
    v_exp_f32 v251, v235
    v_smfmac_f32_32x32x32_bf16 v[192:207], v[104:107], v[240:247], v6
    v_exp_f32 v252, v236
    v_exp_f32 v253, v237
    v_exp_f32 v254, v238
    v_exp_f32 v255, v239
    v_mfma_f32_32x32x16_bf16 v[224:239], v[60:63], v[164:167], 0
    v_exp_f32 v240, v208
    v_exp_f32 v241, v209
    v_exp_f32 v242, v210
    v_exp_f32 v243, v211
    buffer_load_dwordx4 v[80:83], v2, s[20:23], s98 offen
    buffer_load_dwordx3 v[84:86], v2, s[20:23], s98 offen offset:16
    s_add_u32 m0, s44, 0
    s_nop 0
    buffer_load_dwordx4 v1, s[24:27], s96 offen  lds
    buffer_load_dwordx4 v3, s[24:27], s96 offen offset:1024  lds
    v_mfma_f32_32x32x16_bf16 v[224:239], v[56:59], v[160:163], v[224:239]
    v_exp_f32 v244, v212
    v_exp_f32 v245, v213
    v_exp_f32 v246, v214
    v_exp_f32 v247, v215
    v_smfmac_f32_32x32x32_bf16 v[192:207], v[108:111], v[248:255], v6
    v_exp_f32 v248, v216
    v_exp_f32 v249, v217
    v_exp_f32 v250, v218
    v_exp_f32 v251, v219
    s_waitcnt lgkmcnt(0)
    v_smfmac_f32_32x32x32_bf16 v[176:191], v[112:115], v[240:247], v6
    v_exp_f32 v252, v220
    v_exp_f32 v253, v221
    v_exp_f32 v254, v222
    v_exp_f32 v255, v223
    v_mfma_f32_32x32x16_bf16 v[208:223], v[52:55], v[172:175], 0
    v_exp_f32 v240, v224
    v_exp_f32 v241, v225
    v_exp_f32 v242, v226
    v_exp_f32 v243, v227
    ds_write_b128 v7, v[160:163] offset:8192
    ds_write_b128 v7, v[164:167] offset:9216
    buffer_load_dwordx4 v[88:91], v2, s[20:23], s99 offen
    buffer_load_dwordx3 v[92:94], v2, s[20:23], s99 offen offset:16
    s_add_u32 m0, s44, 2048
    s_nop 0
    buffer_load_dwordx4 v1, s[24:27], s97 offen  lds
    buffer_load_dwordx4 v3, s[24:27], s97 offen offset:1024  lds
    v_mfma_f32_32x32x16_bf16 v[208:223], v[48:51], v[168:171], v[208:223]
    v_exp_f32 v244, v228
    v_exp_f32 v245, v229
    v_exp_f32 v246, v230
    v_exp_f32 v247, v231
    v_smfmac_f32_32x32x32_bf16 v[176:191], v[116:119], v[248:255], v6
    v_exp_f32 v248, v232
    v_exp_f32 v249, v233
    v_exp_f32 v250, v234
    v_exp_f32 v251, v235
    v_smfmac_f32_32x32x32_bf16 v[176:191], v[120:123], v[240:247], v6
    v_exp_f32 v252, v236
    v_exp_f32 v253, v237
    v_exp_f32 v254, v238
    v_exp_f32 v255, v239
    v_mfma_f32_32x32x16_bf16 v[224:239], v[60:63], v[172:175], 0
    v_exp_f32 v240, v208
    v_exp_f32 v241, v209
    v_exp_f32 v242, v210
    v_exp_f32 v243, v211
    s_add_u32 m0, s44, 4096
    s_nop 0
    buffer_load_dwordx4 v1, s[24:27], s98 offen  lds
    buffer_load_dwordx4 v3, s[24:27], s98 offen offset:1024  lds
    v_mfma_f32_32x32x16_bf16 v[224:239], v[56:59], v[168:171], v[224:239]
    v_exp_f32 v244, v212
    v_exp_f32 v245, v213
    v_exp_f32 v246, v214
    v_exp_f32 v247, v215
    v_smfmac_f32_32x32x32_bf16 v[176:191], v[124:127], v[248:255], v6
    v_exp_f32 v248, v216
    v_exp_f32 v249, v217
    v_exp_f32 v250, v218
    v_exp_f32 v251, v219
    s_waitcnt vmcnt(10)
    s_setprio 3
    v_smfmac_f32_32x32x32_bf16 v[192:207], v[112:115], v[240:247], v6
    v_exp_f32 v252, v220
    v_exp_f32 v253, v221
    v_exp_f32 v254, v222
    v_exp_f32 v255, v223
    v_dot2_f32_bf16 v14, v64, v64, 0
    v_dot2_f32_bf16 v15, v72, v72, 0
    v_dot2_f32_bf16 v8, v65, v65, 0
    v_dot2_f32_bf16 v9, v73, v73, 0
    v_dot2_f32_bf16 v14, v66, v66, v14
    v_dot2_f32_bf16 v15, v74, v74, v15
    v_dot2_f32_bf16 v8, v67, v67, v8
    v_dot2_f32_bf16 v9, v75, v75, v9
    v_dot2_f32_bf16 v14, v68, v68, v14
    v_dot2_f32_bf16 v15, v76, v76, v15
    v_dot2_f32_bf16 v8, v69, v69, v8
    v_dot2_f32_bf16 v9, v77, v77, v9
    v_dot2_f32_bf16 v14, v70, v70, v14
    v_dot2_f32_bf16 v15, v78, v78, v15
    v_mfma_f32_4x4x4_16b_bf16 v[208:211], v[12:13], v[64:65], 0
    v_exp_f32 v240, v224
    v_add_f32 v14, v14, v8
    v_add_f32 v15, v15, v9
    v_mfma_f32_4x4x4_16b_bf16 v[212:215], v[12:13], v[66:67], 0
    v_exp_f32 v241, v225
    v_permlane32_swap_b32 v14, v15
    v_mfma_f32_4x4x4_16b_bf16 v[216:219], v[12:13], v[68:69], 0
    v_add_f32 v14, v14, v15
    v_mfma_f32_4x4x4_16b_bf16 v[220:223], v[12:13], v[70:71], 0
    v_sqrt_f32 v14, v14
    v_mfma_f32_4x4x4_16b_bf16 v[16:19], v[12:13], v[72:73], 0
    v_exp_f32 v242, v226
    v_add_f32 v14, 0x358637bd, v14
    v_mfma_f32_4x4x4_16b_bf16 v[20:23], v[12:13], v[74:75], 0
    v_rcp_f32 v14, v14
    v_mfma_f32_4x4x4_16b_bf16 v[24:27], v[12:13], v[76:77], 0
    v_exp_f32 v243, v227
    v_mov_b32 v15, v14
    v_mfma_f32_4x4x4_16b_bf16 v[28:31], v[12:13], v[78:79], 0
    v_exp_f32 v244, v228
    v_permlane32_swap_b32 v14, v15
    v_exp_f32 v245, v229
    v_exp_f32 v246, v230
    v_exp_f32 v247, v231
    v_pk_mul_f32 v[208:209], v[208:209], v[14:15] op_sel_hi:[1,0]
    v_pk_mul_f32 v[210:211], v[210:211], v[14:15] op_sel_hi:[1,0]
    v_pk_mul_f32 v[212:213], v[212:213], v[14:15] op_sel_hi:[1,0]
    v_pk_mul_f32 v[214:215], v[214:215], v[14:15] op_sel_hi:[1,0]
    v_pk_mul_f32 v[216:217], v[216:217], v[14:15] op_sel_hi:[1,0]
    v_pk_mul_f32 v[218:219], v[218:219], v[14:15] op_sel_hi:[1,0]
    v_pk_mul_f32 v[220:221], v[220:221], v[14:15] op_sel_hi:[1,0]
    v_pk_mul_f32 v[16:17], v[16:17], v[14:15] op_sel:[0,1]
    v_pk_mul_f32 v[18:19], v[18:19], v[14:15] op_sel:[0,1]
    v_pk_mul_f32 v[20:21], v[20:21], v[14:15] op_sel:[0,1]
    v_pk_mul_f32 v[22:23], v[22:23], v[14:15] op_sel:[0,1]
    v_pk_mul_f32 v[24:25], v[24:25], v[14:15] op_sel:[0,1]
    v_pk_mul_f32 v[26:27], v[26:27], v[14:15] op_sel:[0,1]
    v_pk_mul_f32 v[28:29], v[28:29], v[14:15] op_sel:[0,1]
    s_setprio 2
    v_smfmac_f32_32x32x32_bf16 v[192:207], v[116:119], v[248:255], v6
    v_cvt_pk_bf16_f32 v68, v216, v217
    v_cvt_pk_bf16_f32 v69, v218, v219
    v_cvt_pk_bf16_f32 v70, v220, v221
    v_cvt_pk_bf16_f32 v64, v208, v209
    v_cvt_pk_bf16_f32 v65, v210, v211
    v_cvt_pk_bf16_f32 v66, v212, v213
    v_cvt_pk_bf16_f32 v67, v214, v215
    s_waitcnt vmcnt(2)
    ds_read_b64_tr_b16 v[128:129], v4 offset:0
    ds_read_b64_tr_b16 v[130:131], v4 offset:224
    ds_read_b64_tr_b16 v[132:133], v4 offset:896
    ds_read_b64_tr_b16 v[134:135], v4 offset:1120
    ds_read_b64_tr_b16 v[136:137], v4 offset:2048
    ds_read_b64_tr_b16 v[138:139], v4 offset:2272
    ds_read_b64_tr_b16 v[140:141], v4 offset:2944
    ds_read_b64_tr_b16 v[142:143], v4 offset:3168
    s_add_u32 m0, s44, 6144
    s_nop 0
    buffer_load_dwordx4 v1, s[24:27], s99 offen  lds
    buffer_load_dwordx4 v3, s[24:27], s99 offen offset:1024  lds
    v_mfma_f32_32x32x16_bf16 v[208:223], v[68:71], v[164:167], 0
    v_cvt_pk_bf16_f32 v72, v16, v17
    v_cvt_pk_bf16_f32 v73, v18, v19
    v_cvt_pk_bf16_f32 v74, v20, v21
    v_exp_f32 v248, v232
    v_exp_f32 v249, v233
    v_mfma_f32_32x32x16_bf16 v[208:223], v[64:67], v[160:163], v[208:223]
    v_cvt_pk_bf16_f32 v75, v22, v23
    v_cvt_pk_bf16_f32 v76, v24, v25
    v_cvt_pk_bf16_f32 v77, v26, v27
    v_cvt_pk_bf16_f32 v78, v28, v29
    v_exp_f32 v250, v234
    v_exp_f32 v251, v235
    v_smfmac_f32_32x32x32_bf16 v[192:207], v[120:123], v[240:247], v6
    v_exp_f32 v252, v236
    v_exp_f32 v253, v237
    v_exp_f32 v254, v238
    v_exp_f32 v255, v239
    v_mfma_f32_32x32x16_bf16 v[224:239], v[76:79], v[164:167], 0
    v_exp_f32 v240, v208
    v_exp_f32 v241, v209
    v_exp_f32 v242, v210
    v_exp_f32 v243, v211
    v_mfma_f32_32x32x16_bf16 v[224:239], v[72:75], v[160:163], v[224:239]
    v_exp_f32 v244, v212
    v_exp_f32 v245, v213
    v_exp_f32 v246, v214
    v_exp_f32 v247, v215
    v_smfmac_f32_32x32x32_bf16 v[192:207], v[124:127], v[248:255], v6
    v_exp_f32 v248, v216
    v_exp_f32 v249, v217
    v_exp_f32 v250, v218
    v_exp_f32 v251, v219
    s_waitcnt lgkmcnt(0)
    s_waitcnt vmcnt(6)
    s_setprio 3
    v_smfmac_f32_32x32x32_bf16 v[176:191], v[128:131], v[240:247], v6
    v_exp_f32 v252, v220
    v_exp_f32 v253, v221
    v_exp_f32 v254, v222
    v_exp_f32 v255, v223
    v_dot2_f32_bf16 v14, v80, v80, 0
    v_dot2_f32_bf16 v15, v88, v88, 0
    v_dot2_f32_bf16 v8, v81, v81, 0
    v_dot2_f32_bf16 v9, v89, v89, 0
    v_dot2_f32_bf16 v14, v82, v82, v14
    v_dot2_f32_bf16 v15, v90, v90, v15
    v_dot2_f32_bf16 v8, v83, v83, v8
    v_dot2_f32_bf16 v9, v91, v91, v9
    v_dot2_f32_bf16 v14, v84, v84, v14
    v_dot2_f32_bf16 v15, v92, v92, v15
    v_dot2_f32_bf16 v8, v85, v85, v8
    v_dot2_f32_bf16 v9, v93, v93, v9
    v_dot2_f32_bf16 v14, v86, v86, v14
    v_dot2_f32_bf16 v15, v94, v94, v15
    v_mfma_f32_4x4x4_16b_bf16 v[208:211], v[12:13], v[80:81], 0
    v_exp_f32 v240, v224
    v_add_f32 v14, v14, v8
    v_add_f32 v15, v15, v9
    v_mfma_f32_4x4x4_16b_bf16 v[212:215], v[12:13], v[82:83], 0
    v_exp_f32 v241, v225
    v_permlane32_swap_b32 v14, v15
    v_mfma_f32_4x4x4_16b_bf16 v[216:219], v[12:13], v[84:85], 0
    v_add_f32 v14, v14, v15
    v_mfma_f32_4x4x4_16b_bf16 v[220:223], v[12:13], v[86:87], 0
    v_sqrt_f32 v14, v14
    v_mfma_f32_4x4x4_16b_bf16 v[16:19], v[12:13], v[88:89], 0
    v_exp_f32 v242, v226
    v_add_f32 v14, 0x358637bd, v14
    v_mfma_f32_4x4x4_16b_bf16 v[20:23], v[12:13], v[90:91], 0
    v_rcp_f32 v14, v14
    v_mfma_f32_4x4x4_16b_bf16 v[24:27], v[12:13], v[92:93], 0
    v_exp_f32 v243, v227
    v_mov_b32 v15, v14
    v_mfma_f32_4x4x4_16b_bf16 v[28:31], v[12:13], v[94:95], 0
    v_exp_f32 v244, v228
    v_permlane32_swap_b32 v14, v15
    v_exp_f32 v245, v229
    v_exp_f32 v246, v230
    v_exp_f32 v247, v231
    v_pk_mul_f32 v[208:209], v[208:209], v[14:15] op_sel_hi:[1,0]
    v_pk_mul_f32 v[210:211], v[210:211], v[14:15] op_sel_hi:[1,0]
    v_pk_mul_f32 v[212:213], v[212:213], v[14:15] op_sel_hi:[1,0]
    v_pk_mul_f32 v[214:215], v[214:215], v[14:15] op_sel_hi:[1,0]
    v_pk_mul_f32 v[216:217], v[216:217], v[14:15] op_sel_hi:[1,0]
    v_pk_mul_f32 v[218:219], v[218:219], v[14:15] op_sel_hi:[1,0]
    v_pk_mul_f32 v[220:221], v[220:221], v[14:15] op_sel_hi:[1,0]
    v_pk_mul_f32 v[16:17], v[16:17], v[14:15] op_sel:[0,1]
    v_pk_mul_f32 v[18:19], v[18:19], v[14:15] op_sel:[0,1]
    v_pk_mul_f32 v[20:21], v[20:21], v[14:15] op_sel:[0,1]
    v_pk_mul_f32 v[22:23], v[22:23], v[14:15] op_sel:[0,1]
    v_pk_mul_f32 v[24:25], v[24:25], v[14:15] op_sel:[0,1]
    v_pk_mul_f32 v[26:27], v[26:27], v[14:15] op_sel:[0,1]
    v_pk_mul_f32 v[28:29], v[28:29], v[14:15] op_sel:[0,1]
    s_setprio 2
    v_smfmac_f32_32x32x32_bf16 v[176:191], v[132:135], v[248:255], v6
    v_cvt_pk_bf16_f32 v84, v216, v217
    v_cvt_pk_bf16_f32 v85, v218, v219
    v_cvt_pk_bf16_f32 v86, v220, v221
    v_cvt_pk_bf16_f32 v80, v208, v209
    v_cvt_pk_bf16_f32 v81, v210, v211
    v_cvt_pk_bf16_f32 v82, v212, v213
    v_cvt_pk_bf16_f32 v83, v214, v215
    s_waitcnt vmcnt(0)
    ds_read_b64_tr_b16 v[144:145], v4 offset:4096
    ds_read_b64_tr_b16 v[146:147], v4 offset:4320
    ds_read_b64_tr_b16 v[148:149], v4 offset:4992
    ds_read_b64_tr_b16 v[150:151], v4 offset:5216
    ds_read_b64_tr_b16 v[152:153], v4 offset:6144
    ds_read_b64_tr_b16 v[154:155], v4 offset:6368
    ds_read_b64_tr_b16 v[156:157], v4 offset:7040
    ds_read_b64_tr_b16 v[158:159], v4 offset:7264
    v_mfma_f32_32x32x16_bf16 v[208:223], v[84:87], v[164:167], 0
    v_cvt_pk_bf16_f32 v88, v16, v17
    v_cvt_pk_bf16_f32 v89, v18, v19
    v_cvt_pk_bf16_f32 v90, v20, v21
    v_exp_f32 v248, v232
    v_exp_f32 v249, v233
    v_mfma_f32_32x32x16_bf16 v[208:223], v[80:83], v[160:163], v[208:223]
    v_cvt_pk_bf16_f32 v91, v22, v23
    v_cvt_pk_bf16_f32 v92, v24, v25
    v_cvt_pk_bf16_f32 v93, v26, v27
    v_cvt_pk_bf16_f32 v94, v28, v29
    v_exp_f32 v250, v234
    v_exp_f32 v251, v235
    v_smfmac_f32_32x32x32_bf16 v[176:191], v[136:139], v[240:247], v6
    v_exp_f32 v252, v236
    v_exp_f32 v253, v237
    v_exp_f32 v254, v238
    v_exp_f32 v255, v239
    v_mfma_f32_32x32x16_bf16 v[224:239], v[92:95], v[164:167], 0
    v_exp_f32 v240, v208
    v_exp_f32 v241, v209
    v_exp_f32 v242, v210
    v_exp_f32 v243, v211
    v_mfma_f32_32x32x16_bf16 v[224:239], v[88:91], v[160:163], v[224:239]
    v_exp_f32 v244, v212
    v_exp_f32 v245, v213
    v_exp_f32 v246, v214
    v_exp_f32 v247, v215
    v_smfmac_f32_32x32x32_bf16 v[176:191], v[140:143], v[248:255], v6
    v_exp_f32 v248, v216
    v_exp_f32 v249, v217
    v_exp_f32 v250, v218
    v_exp_f32 v251, v219
    s_waitcnt lgkmcnt(0)
    v_smfmac_f32_32x32x32_bf16 v[176:191], v[144:147], v[240:247], v6
    v_exp_f32 v252, v220
    v_exp_f32 v253, v221
    v_exp_f32 v254, v222
    v_exp_f32 v255, v223
    v_mfma_f32_32x32x16_bf16 v[208:223], v[68:71], v[172:175], 0
    v_exp_f32 v240, v224
    v_exp_f32 v241, v225
    v_exp_f32 v242, v226
    v_exp_f32 v243, v227
    v_mfma_f32_32x32x16_bf16 v[208:223], v[64:67], v[168:171], v[208:223]
    v_exp_f32 v244, v228
    v_exp_f32 v245, v229
    v_exp_f32 v246, v230
    v_exp_f32 v247, v231
    v_smfmac_f32_32x32x32_bf16 v[176:191], v[148:151], v[248:255], v6
    v_exp_f32 v248, v232
    v_exp_f32 v249, v233
    v_exp_f32 v250, v234
    v_exp_f32 v251, v235
    v_smfmac_f32_32x32x32_bf16 v[176:191], v[152:155], v[240:247], v6
    v_exp_f32 v252, v236
    v_exp_f32 v253, v237
    v_exp_f32 v254, v238
    v_exp_f32 v255, v239
    v_mfma_f32_32x32x16_bf16 v[224:239], v[76:79], v[172:175], 0
    v_exp_f32 v240, v208
    v_exp_f32 v241, v209
    v_exp_f32 v242, v210
    v_exp_f32 v243, v211
    v_mfma_f32_32x32x16_bf16 v[224:239], v[72:75], v[168:171], v[224:239]
    v_exp_f32 v244, v212
    v_exp_f32 v245, v213
    v_exp_f32 v246, v214
    v_exp_f32 v247, v215
    v_smfmac_f32_32x32x32_bf16 v[176:191], v[156:159], v[248:255], v6
    v_exp_f32 v248, v216
    v_exp_f32 v249, v217
    v_exp_f32 v250, v218
    v_exp_f32 v251, v219
    v_smfmac_f32_32x32x32_bf16 v[192:207], v[128:131], v[240:247], v6
    v_exp_f32 v252, v220
    v_exp_f32 v253, v221
    v_exp_f32 v254, v222
    v_exp_f32 v255, v223
    v_mfma_f32_32x32x16_bf16 v[208:223], v[84:87], v[172:175], 0
    v_exp_f32 v240, v224
    v_exp_f32 v241, v225
    v_exp_f32 v242, v226
    v_exp_f32 v243, v227
    ds_write_b128 v7, v[176:179] offset:0
    ds_write_b128 v7, v[180:183] offset:1024
    ds_write_b128 v7, v[184:187] offset:2048
    ds_write_b128 v7, v[188:191] offset:3072
    s_and_b32 s55, s48, 0xffff
    s_lshr_b64 s[48:49], s[48:49], 16
    s_add_u32 s58, s58, 1
    v_mfma_f32_32x32x16_bf16 v[208:223], v[80:83], v[168:171], v[208:223]
    v_exp_f32 v244, v228
    v_exp_f32 v245, v229
    v_exp_f32 v246, v230
    v_exp_f32 v247, v231
    v_smfmac_f32_32x32x32_bf16 v[192:207], v[132:135], v[248:255], v6
    v_exp_f32 v248, v232
    v_exp_f32 v249, v233
    v_exp_f32 v250, v234
    v_exp_f32 v251, v235
    ds_add_u32 v7, v5 offset:12288
    v_mov_b32 v11, v7
    v_add_lshl_u32 v7, s55, v0, 4
    v_smfmac_f32_32x32x32_bf16 v[192:207], v[136:139], v[240:247], v6
    v_exp_f32 v252, v236
    v_exp_f32 v253, v237
    v_exp_f32 v254, v238
    v_exp_f32 v255, v239
    v_mfma_f32_32x32x16_bf16 v[224:239], v[92:95], v[172:175], 0
    v_exp_f32 v240, v208
    v_exp_f32 v241, v209
    v_exp_f32 v242, v210
    v_exp_f32 v243, v211
    ds_read_b32 v9, v7 offset:12288
    ds_read_b128 v[160:163], v7 offset:8192
    ds_read_b128 v[164:167], v7 offset:9216
    ds_read_b128 v[176:179], v7 offset:0
    ds_read_b128 v[180:183], v7 offset:1024
    ds_read_b128 v[184:187], v7 offset:2048
    ds_read_b128 v[188:191], v7 offset:3072
    v_mfma_f32_32x32x16_bf16 v[224:239], v[88:91], v[168:171], v[224:239]
    v_exp_f32 v244, v212
    v_exp_f32 v245, v213
    v_exp_f32 v246, v214
    v_exp_f32 v247, v215
    v_smfmac_f32_32x32x32_bf16 v[192:207], v[140:143], v[248:255], v6
    v_exp_f32 v248, v216
    v_exp_f32 v249, v217
    v_exp_f32 v250, v218
    v_exp_f32 v251, v219
    v_smfmac_f32_32x32x32_bf16 v[192:207], v[144:147], v[240:247], v6
    v_exp_f32 v252, v220
    v_exp_f32 v253, v221
    s_waitcnt lgkmcnt(0)
    v_cmp_le_u32 vcc, s58, v9
    v_exp_f32 v254, v222
    v_exp_f32 v255, v223
    s_cbranch_vccz L_redoF
L_okF:
    v_mfma_f32_32x32x16_bf16 v[208:223], v[36:39], v[164:167], 0
    v_exp_f32 v240, v224
    v_exp_f32 v241, v225
    v_exp_f32 v242, v226
    v_exp_f32 v243, v227
    v_mfma_f32_32x32x16_bf16 v[208:223], v[32:35], v[160:163], v[208:223]
    v_exp_f32 v244, v228
    v_exp_f32 v245, v229
    v_exp_f32 v246, v230
    v_exp_f32 v247, v231
    v_smfmac_f32_32x32x32_bf16 v[192:207], v[148:151], v[248:255], v6
    v_exp_f32 v248, v232
    v_exp_f32 v249, v233
    v_exp_f32 v250, v234
    v_exp_f32 v251, v235
    v_smfmac_f32_32x32x32_bf16 v[192:207], v[152:155], v[240:247], v6
    v_exp_f32 v252, v236
    v_exp_f32 v253, v237
    v_exp_f32 v254, v238
    v_exp_f32 v255, v239
    s_cmp_lt_u32 s3, 4
    s_cbranch_scc0 L_pf0
    s_setprio 1
L_pf0:
.p2align 6
L_loop:
    v_mfma_f32_32x32x16_bf16 v[224:239], v[44:47], v[164:167], 0
    v_exp_f32 v240, v208
    v_exp_f32 v241, v209
    v_exp_f32 v242, v210
    v_exp_f32 v243, v211
    v_mfma_f32_32x32x16_bf16 v[224:239], v[40:43], v[160:163], v[224:239]
    v_exp_f32 v244, v212
    v_exp_f32 v245, v213
    v_exp_f32 v246, v214
    v_exp_f32 v247, v215
    v_smfmac_f32_32x32x32_bf16 v[192:207], v[156:159], v[248:255], v6
    v_exp_f32 v248, v216
    v_exp_f32 v249, v217
    v_exp_f32 v250, v218
    v_exp_f32 v251, v219
    v_smfmac_f32_32x32x32_bf16 v[176:191], v[96:99], v[240:247], v6
    v_exp_f32 v252, v220
    v_exp_f32 v253, v221
    v_exp_f32 v254, v222
    v_exp_f32 v255, v223
    v_mfma_f32_32x32x16_bf16 v[208:223], v[52:55], v[164:167], 0
    v_exp_f32 v240, v224
    v_exp_f32 v241, v225
    v_exp_f32 v242, v226
    v_exp_f32 v243, v227
    ds_write_b128 v11, v[192:195] offset:4096
    ds_write_b128 v11, v[196:199] offset:5120
    ds_write_b128 v11, v[200:203] offset:6144
    ds_write_b128 v11, v[204:207] offset:7168
    s_add_u32 s58, s58, 1
    s_add_u32 s56, s58, s59
    s_cmp_lg_u32 s56, 23
    s_cbranch_scc1 L_pr51
    s_setprio 0
L_pr51:
    v_mfma_f32_32x32x16_bf16 v[208:223], v[48:51], v[160:163], v[208:223]
    v_exp_f32 v244, v228
    v_exp_f32 v245, v229
    v_exp_f32 v246, v230
    v_exp_f32 v247, v231
    v_smfmac_f32_32x32x32_bf16 v[176:191], v[100:103], v[248:255], v6
    v_exp_f32 v248, v232
    v_exp_f32 v249, v233
    v_exp_f32 v250, v234
    v_exp_f32 v251, v235
    ds_add_u32 v11, v5 offset:12288
    v_smfmac_f32_32x32x32_bf16 v[176:191], v[104:107], v[240:247], v6
    v_exp_f32 v252, v236
    v_exp_f32 v253, v237
    v_exp_f32 v254, v238
    v_exp_f32 v255, v239
    v_mfma_f32_32x32x16_bf16 v[224:239], v[60:63], v[164:167], 0
    v_exp_f32 v240, v208
    v_exp_f32 v241, v209
    v_exp_f32 v242, v210
    v_exp_f32 v243, v211
    v_mfma_f32_32x32x16_bf16 v[224:239], v[56:59], v[160:163], v[224:239]
    v_exp_f32 v244, v212
    v_exp_f32 v245, v213
    v_exp_f32 v246, v214
    v_exp_f32 v247, v215
    v_smfmac_f32_32x32x32_bf16 v[176:191], v[108:111], v[248:255], v6
    v_exp_f32 v248, v216
    v_exp_f32 v249, v217
    v_exp_f32 v250, v218
    v_exp_f32 v251, v219
    v_smfmac_f32_32x32x32_bf16 v[176:191], v[112:115], v[240:247], v6
    v_exp_f32 v252, v220
    v_exp_f32 v253, v221
    v_exp_f32 v254, v222
    v_exp_f32 v255, v223
    v_mfma_f32_32x32x16_bf16 v[208:223], v[68:71], v[164:167], 0
    v_exp_f32 v240, v224
    v_exp_f32 v241, v225
    v_exp_f32 v242, v226
    v_exp_f32 v243, v227
    v_mfma_f32_32x32x16_bf16 v[208:223], v[64:67], v[160:163], v[208:223]
    v_exp_f32 v244, v228
    v_exp_f32 v245, v229
    v_exp_f32 v246, v230
    v_exp_f32 v247, v231
    v_smfmac_f32_32x32x32_bf16 v[176:191], v[116:119], v[248:255], v6
    v_exp_f32 v248, v232
    v_exp_f32 v249, v233
    v_exp_f32 v250, v234
    v_exp_f32 v251, v235
    v_smfmac_f32_32x32x32_bf16 v[176:191], v[120:123], v[240:247], v6
    v_exp_f32 v252, v236
    v_exp_f32 v253, v237
    v_exp_f32 v254, v238
    v_exp_f32 v255, v239
    v_mfma_f32_32x32x16_bf16 v[224:239], v[76:79], v[164:167], 0
    v_exp_f32 v240, v208
    v_exp_f32 v241, v209
    v_exp_f32 v242, v210
    v_exp_f32 v243, v211
    ds_read_b32 v9, v7 offset:12288
    ds_read_b128 v[168:171], v7 offset:10240
    ds_read_b128 v[172:175], v7 offset:11264
    ds_read_b128 v[192:195], v7 offset:4096
    ds_read_b128 v[196:199], v7 offset:5120
    ds_read_b128 v[200:203], v7 offset:6144
    ds_read_b128 v[204:207], v7 offset:7168
    v_mfma_f32_32x32x16_bf16 v[224:239], v[72:75], v[160:163], v[224:239]
    v_exp_f32 v244, v212
    v_exp_f32 v245, v213
    v_exp_f32 v246, v214
    v_exp_f32 v247, v215
    v_smfmac_f32_32x32x32_bf16 v[176:191], v[124:127], v[248:255], v6
    v_exp_f32 v248, v216
    v_exp_f32 v249, v217
    v_exp_f32 v250, v218
    v_exp_f32 v251, v219
    v_smfmac_f32_32x32x32_bf16 v[176:191], v[128:131], v[240:247], v6
    v_exp_f32 v252, v220
    v_exp_f32 v253, v221
    v_exp_f32 v254, v222
    v_exp_f32 v255, v223
    v_mfma_f32_32x32x16_bf16 v[208:223], v[84:87], v[164:167], 0
    v_exp_f32 v240, v224
    v_exp_f32 v241, v225
    v_exp_f32 v242, v226
    v_exp_f32 v243, v227
    v_mfma_f32_32x32x16_bf16 v[208:223], v[80:83], v[160:163], v[208:223]
    v_exp_f32 v244, v228
    v_exp_f32 v245, v229
    v_exp_f32 v246, v230
    v_exp_f32 v247, v231
    v_smfmac_f32_32x32x32_bf16 v[176:191], v[132:135], v[248:255], v6
    v_exp_f32 v248, v232
    v_exp_f32 v249, v233
    v_exp_f32 v250, v234
    v_exp_f32 v251, v235
    v_smfmac_f32_32x32x32_bf16 v[176:191], v[136:139], v[240:247], v6
    v_exp_f32 v252, v236
    v_exp_f32 v253, v237
    v_exp_f32 v254, v238
    v_exp_f32 v255, v239
    v_mfma_f32_32x32x16_bf16 v[224:239], v[92:95], v[164:167], 0
    v_exp_f32 v240, v208
    v_exp_f32 v241, v209
    v_exp_f32 v242, v210
    v_exp_f32 v243, v211
    v_mfma_f32_32x32x16_bf16 v[224:239], v[88:91], v[160:163], v[224:239]
    v_exp_f32 v244, v212
    v_exp_f32 v245, v213
    v_exp_f32 v246, v214
    v_exp_f32 v247, v215
    v_smfmac_f32_32x32x32_bf16 v[176:191], v[140:143], v[248:255], v6
    v_exp_f32 v248, v216
    v_exp_f32 v249, v217
    v_exp_f32 v250, v218
    v_exp_f32 v251, v219
    s_waitcnt lgkmcnt(0)
    v_cmp_le_u32 vcc, s58, v9
    v_smfmac_f32_32x32x32_bf16 v[176:191], v[144:147], v[240:247], v6
    v_exp_f32 v252, v220
    v_exp_f32 v253, v221
    v_exp_f32 v254, v222
    v_exp_f32 v255, v223
    s_cbranch_vccz L_redo0
L_ok0:
    v_mfma_f32_32x32x16_bf16 v[208:223], v[36:39], v[172:175], 0
    v_exp_f32 v240, v224
    v_exp_f32 v241, v225
    v_exp_f32 v242, v226
    v_exp_f32 v243, v227
    v_mfma_f32_32x32x16_bf16 v[208:223], v[32:35], v[168:171], v[208:223]
    v_exp_f32 v244, v228
    v_exp_f32 v245, v229
    v_exp_f32 v246, v230
    v_exp_f32 v247, v231
    v_smfmac_f32_32x32x32_bf16 v[176:191], v[148:151], v[248:255], v6
    v_exp_f32 v248, v232
    v_exp_f32 v249, v233
    v_exp_f32 v250, v234
    v_exp_f32 v251, v235
    v_smfmac_f32_32x32x32_bf16 v[176:191], v[152:155], v[240:247], v6
    v_exp_f32 v252, v236
    v_exp_f32 v253, v237
    v_exp_f32 v254, v238
    v_exp_f32 v255, v239
    v_mfma_f32_32x32x16_bf16 v[224:239], v[44:47], v[172:175], 0
    v_exp_f32 v240, v208
    v_exp_f32 v241, v209
    v_exp_f32 v242, v210
    v_exp_f32 v243, v211
    v_mfma_f32_32x32x16_bf16 v[224:239], v[40:43], v[168:171], v[224:239]
    v_exp_f32 v244, v212
    v_exp_f32 v245, v213
    v_exp_f32 v246, v214
    v_exp_f32 v247, v215
    v_smfmac_f32_32x32x32_bf16 v[176:191], v[156:159], v[248:255], v6
    v_exp_f32 v248, v216
    v_exp_f32 v249, v217
    v_exp_f32 v250, v218
    v_exp_f32 v251, v219
    v_smfmac_f32_32x32x32_bf16 v[192:207], v[96:99], v[240:247], v6
    v_exp_f32 v252, v220
    v_exp_f32 v253, v221
    v_exp_f32 v254, v222
    v_exp_f32 v255, v223
    v_mfma_f32_32x32x16_bf16 v[208:223], v[52:55], v[172:175], 0
    v_exp_f32 v240, v224
    v_exp_f32 v241, v225
    v_exp_f32 v242, v226
    v_exp_f32 v243, v227
    ds_write_b128 v7, v[176:179] offset:0
    ds_write_b128 v7, v[180:183] offset:1024
    ds_write_b128 v7, v[184:187] offset:2048
    ds_write_b128 v7, v[188:191] offset:3072
    s_and_b32 s55, s48, 0xffff
    s_lshr_b64 s[48:49], s[48:49], 16
    s_add_u32 s58, s58, 1
    v_mfma_f32_32x32x16_bf16 v[208:223], v[48:51], v[168:171], v[208:223]
    v_exp_f32 v244, v228
    v_exp_f32 v245, v229
    v_exp_f32 v246, v230
    v_exp_f32 v247, v231
    v_smfmac_f32_32x32x32_bf16 v[192:207], v[100:103], v[248:255], v6
    v_exp_f32 v248, v232
    v_exp_f32 v249, v233
    v_exp_f32 v250, v234
    v_exp_f32 v251, v235
    ds_add_u32 v7, v5 offset:12288
    v_mov_b32 v11, v7
    v_add_lshl_u32 v7, s55, v0, 4
    v_smfmac_f32_32x32x32_bf16 v[192:207], v[104:107], v[240:247], v6
    v_exp_f32 v252, v236
    v_exp_f32 v253, v237
    v_exp_f32 v254, v238
    v_exp_f32 v255, v239
    v_mfma_f32_32x32x16_bf16 v[224:239], v[60:63], v[172:175], 0
    v_exp_f32 v240, v208
    v_exp_f32 v241, v209
    v_exp_f32 v242, v210
    v_exp_f32 v243, v211
    v_mfma_f32_32x32x16_bf16 v[224:239], v[56:59], v[168:171], v[224:239]
    v_exp_f32 v244, v212
    v_exp_f32 v245, v213
    v_exp_f32 v246, v214
    v_exp_f32 v247, v215
    v_smfmac_f32_32x32x32_bf16 v[192:207], v[108:111], v[248:255], v6
    v_exp_f32 v248, v216
    v_exp_f32 v249, v217
    v_exp_f32 v250, v218
    v_exp_f32 v251, v219
    v_smfmac_f32_32x32x32_bf16 v[192:207], v[112:115], v[240:247], v6
    v_exp_f32 v252, v220
    v_exp_f32 v253, v221
    v_exp_f32 v254, v222
    v_exp_f32 v255, v223
    v_mfma_f32_32x32x16_bf16 v[208:223], v[68:71], v[172:175], 0
    v_exp_f32 v240, v224
    v_exp_f32 v241, v225
    v_exp_f32 v242, v226
    v_exp_f32 v243, v227
    v_mfma_f32_32x32x16_bf16 v[208:223], v[64:67], v[168:171], v[208:223]
    v_exp_f32 v244, v228
    v_exp_f32 v245, v229
    v_exp_f32 v246, v230
    v_exp_f32 v247, v231
    v_smfmac_f32_32x32x32_bf16 v[192:207], v[116:119], v[248:255], v6
    v_exp_f32 v248, v232
    v_exp_f32 v249, v233
    v_exp_f32 v250, v234
    v_exp_f32 v251, v235
    v_smfmac_f32_32x32x32_bf16 v[192:207], v[120:123], v[240:247], v6
    v_exp_f32 v252, v236
    v_exp_f32 v253, v237
    v_exp_f32 v254, v238
    v_exp_f32 v255, v239
    v_mfma_f32_32x32x16_bf16 v[224:239], v[76:79], v[172:175], 0
    v_exp_f32 v240, v208
    v_exp_f32 v241, v209
    v_exp_f32 v242, v210
    v_exp_f32 v243, v211
    ds_read_b32 v9, v7 offset:12288
    ds_read_b128 v[160:163], v7 offset:8192
    ds_read_b128 v[164:167], v7 offset:9216
    ds_read_b128 v[176:179], v7 offset:0
    ds_read_b128 v[180:183], v7 offset:1024
    ds_read_b128 v[184:187], v7 offset:2048
    ds_read_b128 v[188:191], v7 offset:3072
    v_mfma_f32_32x32x16_bf16 v[224:239], v[72:75], v[168:171], v[224:239]
    v_exp_f32 v244, v212
    v_exp_f32 v245, v213
    v_exp_f32 v246, v214
    v_exp_f32 v247, v215
    v_smfmac_f32_32x32x32_bf16 v[192:207], v[124:127], v[248:255], v6
    v_exp_f32 v248, v216
    v_exp_f32 v249, v217
    v_exp_f32 v250, v218
    v_exp_f32 v251, v219
    v_smfmac_f32_32x32x32_bf16 v[192:207], v[128:131], v[240:247], v6
    v_exp_f32 v252, v220
    v_exp_f32 v253, v221
    v_exp_f32 v254, v222
    v_exp_f32 v255, v223
    v_mfma_f32_32x32x16_bf16 v[208:223], v[84:87], v[172:175], 0
    v_exp_f32 v240, v224
    v_exp_f32 v241, v225
    v_exp_f32 v242, v226
    v_exp_f32 v243, v227
    v_mfma_f32_32x32x16_bf16 v[208:223], v[80:83], v[168:171], v[208:223]
    v_exp_f32 v244, v228
    v_exp_f32 v245, v229
    v_exp_f32 v246, v230
    v_exp_f32 v247, v231
    v_smfmac_f32_32x32x32_bf16 v[192:207], v[132:135], v[248:255], v6
    v_exp_f32 v248, v232
    v_exp_f32 v249, v233
    v_exp_f32 v250, v234
    v_exp_f32 v251, v235
    v_smfmac_f32_32x32x32_bf16 v[192:207], v[136:139], v[240:247], v6
    v_exp_f32 v252, v236
    v_exp_f32 v253, v237
    v_exp_f32 v254, v238
    v_exp_f32 v255, v239
    v_mfma_f32_32x32x16_bf16 v[224:239], v[92:95], v[172:175], 0
    v_exp_f32 v240, v208
    v_exp_f32 v241, v209
    v_exp_f32 v242, v210
    v_exp_f32 v243, v211
    v_mfma_f32_32x32x16_bf16 v[224:239], v[88:91], v[168:171], v[224:239]
    v_exp_f32 v244, v212
    v_exp_f32 v245, v213
    v_exp_f32 v246, v214
    v_exp_f32 v247, v215
    v_smfmac_f32_32x32x32_bf16 v[192:207], v[140:143], v[248:255], v6
    v_exp_f32 v248, v216
    v_exp_f32 v249, v217
    v_exp_f32 v250, v218
    v_exp_f32 v251, v219
    s_waitcnt lgkmcnt(0)
    v_cmp_le_u32 vcc, s58, v9
    v_smfmac_f32_32x32x32_bf16 v[192:207], v[144:147], v[240:247], v6
    v_exp_f32 v252, v220
    v_exp_f32 v253, v221
    v_exp_f32 v254, v222
    v_exp_f32 v255, v223
    s_cbranch_vccz L_redo1
L_ok1:
    s_cmp_lg_u32 s58, 8
    v_mfma_f32_32x32x16_bf16 v[208:223], v[36:39], v[164:167], 0
    v_exp_f32 v240, v224
    v_exp_f32 v241, v225
    v_exp_f32 v242, v226
    v_exp_f32 v243, v227
    v_mfma_f32_32x32x16_bf16 v[208:223], v[32:35], v[160:163], v[208:223]
    v_exp_f32 v244, v228
    v_exp_f32 v245, v229
    v_exp_f32 v246, v230
    v_exp_f32 v247, v231
    v_smfmac_f32_32x32x32_bf16 v[192:207], v[148:151], v[248:255], v6
    v_exp_f32 v248, v232
    v_exp_f32 v249, v233
    v_exp_f32 v250, v234
    v_exp_f32 v251, v235
    v_smfmac_f32_32x32x32_bf16 v[192:207], v[152:155], v[240:247], v6
    v_exp_f32 v252, v236
    v_exp_f32 v253, v237
    v_exp_f32 v254, v238
    v_exp_f32 v255, v239
    s_cbranch_scc1 L_loop
    s_setprio 3
    v_smfmac_f32_32x32x32_bf16 v[192:207], v[156:159], v[248:255], v6
L_fin:
    s_mul_i32 s36, s54, 1792
    s_add_u32 s36, s36, s35
    v_lshrrev_b32 v17, 5, v0
    v_lshl_add_u32 v16, v17, 2, v2
    v_sub_u32 v18, v11, v1
    v_add_u32 v16, 0x1000, v16
    v_add_u32 v18, v18, v16
    v_lshl_add_u32 v19, v17, 11, v18
    s_nop 3
    v_pk_add_f32 v[206:207], v[206:207], v[190:191]
    v_pk_add_f32 v[204:205], v[204:205], v[188:189]
    v_mov_b32 v15, v204
    v_mov_b32 v14, v204
    v_pk_add_f32 v[202:203], v[202:203], v[186:187]
    v_pk_add_f32 v[200:201], v[200:201], v[184:185]
    v_permlane32_swap_b32 v15, v14
    v_rcp_f32 v14, v14
    v_pk_add_f32 v[198:199], v[198:199], v[182:183]
    v_pk_add_f32 v[196:197], v[196:197], v[180:181]
    v_pk_add_f32 v[194:195], v[194:195], v[178:179]
    v_pk_add_f32 v[192:193], v[192:193], v[176:177]
    v_pk_mul_f32 v[192:193], v[192:193], v[14:15] op_sel_hi:[1,0]
    v_pk_mul_f32 v[194:195], v[194:195], v[14:15] op_sel_hi:[1,0]
    v_pk_mul_f32 v[196:197], v[196:197], v[14:15] op_sel_hi:[1,0]
    v_pk_mul_f32 v[198:199], v[198:199], v[14:15] op_sel_hi:[1,0]
    v_pk_mul_f32 v[200:201], v[200:201], v[14:15] op_sel_hi:[1,0]
    v_pk_mul_f32 v[202:203], v[202:203], v[14:15] op_sel_hi:[1,0]
    v_pk_mul_f32 v[204:205], v[204:205], v[14:15] op_sel_hi:[1,0]
    v_pk_mul_f32 v[206:207], v[206:207], v[14:15] op_sel_hi:[1,0]
    v_cvt_pk_bf16_f32 v20, v192, v193
    v_cvt_pk_bf16_f32 v21, v194, v195
    v_cvt_pk_bf16_f32 v22, v196, v197
    v_cvt_pk_bf16_f32 v23, v198, v199
    v_cvt_pk_bf16_f32 v24, v200, v201
    v_cvt_pk_bf16_f32 v25, v202, v203
    v_cvt_pk_bf16_f32 v26, v204, v205
    v_cvt_pk_bf16_f32 v27, v206, v207
    ds_write2_b64 v18, v[20:21], v[22:23] offset0:0 offset1:1
    ds_write_b64 v18, v[24:25] offset:16
    ds_write_b64 v19, v[26:27] offset:24
    ds_read_b128 v[192:195], v11 offset:4096
    ds_read_b128 v[196:199], v11 offset:5120
    s_waitcnt lgkmcnt(1)
    buffer_store_dwordx4 v[192:195], v1, s[28:31], s36 offen sc1
    s_waitcnt lgkmcnt(0)
    buffer_store_dwordx4 v[196:199], v3, s[28:31], s36 offen offset:1024 sc1
L_end:
    s_endpgm
L_redoF:
    s_sub_u32 s57, s57, 1
    s_cbranch_scc1 L_end
    ds_read_b32 v9, v7 offset:12288
    ds_read_b128 v[160:163], v7 offset:8192
    ds_read_b128 v[164:167], v7 offset:9216
    ds_read_b128 v[176:179], v7 offset:0
    ds_read_b128 v[180:183], v7 offset:1024
    ds_read_b128 v[184:187], v7 offset:2048
    ds_read_b128 v[188:191], v7 offset:3072
    s_waitcnt lgkmcnt(0)
    v_cmp_le_u32 vcc, s58, v9
    s_nop 4
    s_cbranch_vccz L_redoF
    s_branch L_okF
L_redo0:
    s_sub_u32 s57, s57, 1
    s_cbranch_scc1 L_end
    ds_read_b32 v9, v7 offset:12288
    ds_read_b128 v[168:171], v7 offset:10240
    ds_read_b128 v[172:175], v7 offset:11264
    ds_read_b128 v[192:195], v7 offset:4096
    ds_read_b128 v[196:199], v7 offset:5120
    ds_read_b128 v[200:203], v7 offset:6144
    ds_read_b128 v[204:207], v7 offset:7168
    s_waitcnt lgkmcnt(0)
    v_cmp_le_u32 vcc, s58, v9
    s_nop 4
    s_cbranch_vccz L_redo0
    s_branch L_ok0
L_redo1:
    s_sub_u32 s57, s57, 1
    s_cbranch_scc1 L_end
    ds_read_b32 v9, v7 offset:12288
    ds_read_b128 v[160:163], v7 offset:8192
    ds_read_b128 v[164:167], v7 offset:9216
    ds_read_b128 v[176:179], v7 offset:0
    ds_read_b128 v[180:183], v7 offset:1024
    ds_read_b128 v[184:187], v7 offset:2048
    ds_read_b128 v[188:191], v7 offset:3072
    s_waitcnt lgkmcnt(0)
    v_cmp_le_u32 vcc, s58, v9
    s_nop 4
    s_cbranch_vccz L_redo1
    s_branch L_ok1
L_slow:
    v_mov_b32 v167, 0
    s_mov_b32 s54, s3
    buffer_load_dwordx4 v[48:51], v2, s[20:23], s94 offen
    buffer_load_dwordx3 v[52:54], v2, s[20:23], s94 offen offset:16
    buffer_load_dwordx4 v[56:59], v2, s[20:23], s95 offen
    buffer_load_dwordx3 v[60:62], v2, s[20:23], s95 offen offset:16
    buffer_load_dwordx4 v[64:67], v2, s[20:23], s96 offen
    buffer_load_dwordx3 v[68:70], v2, s[20:23], s96 offen offset:16
    buffer_load_dwordx4 v[72:75], v2, s[20:23], s97 offen
    buffer_load_dwordx3 v[76:78], v2, s[20:23], s97 offen offset:16
    buffer_load_dwordx4 v[80:83], v2, s[20:23], s98 offen
    buffer_load_dwordx3 v[84:86], v2, s[20:23], s98 offen offset:16
    buffer_load_dwordx4 v[88:91], v2, s[20:23], s99 offen
    buffer_load_dwordx3 v[92:94], v2, s[20:23], s99 offen offset:16
    s_add_u32 m0, s44, 4096
    s_nop 0
    buffer_load_dwordx4 v1, s[24:27], s94 offen  lds
    buffer_load_dwordx4 v3, s[24:27], s94 offen offset:1024  lds
    s_add_u32 m0, s44, 6144
    s_nop 0
    buffer_load_dwordx4 v1, s[24:27], s95 offen  lds
    buffer_load_dwordx4 v3, s[24:27], s95 offen offset:1024  lds
    s_waitcnt vmcnt(0)
    ds_read_b64_tr_b16 v[96:97], v4 offset:0
    ds_read_b64_tr_b16 v[98:99], v4 offset:224
    ds_read_b64_tr_b16 v[100:101], v4 offset:896
    ds_read_b64_tr_b16 v[102:103], v4 offset:1120
    ds_read_b64_tr_b16 v[104:105], v4 offset:2048
    ds_read_b64_tr_b16 v[106:107], v4 offset:2272
    ds_read_b64_tr_b16 v[108:109], v4 offset:2944
    ds_read_b64_tr_b16 v[110:111], v4 offset:3168
    ds_read_b64_tr_b16 v[112:113], v4 offset:4096
    ds_read_b64_tr_b16 v[114:115], v4 offset:4320
    ds_read_b64_tr_b16 v[116:117], v4 offset:4992
    ds_read_b64_tr_b16 v[118:119], v4 offset:5216
    ds_read_b64_tr_b16 v[120:121], v4 offset:6144
    ds_read_b64_tr_b16 v[122:123], v4 offset:6368
    ds_read_b64_tr_b16 v[124:125], v4 offset:7040
    ds_read_b64_tr_b16 v[126:127], v4 offset:7264
    s_waitcnt lgkmcnt(0)
    s_add_u32 m0, s44, 0
    s_nop 0
    buffer_load_dwordx4 v1, s[24:27], s96 offen  lds
    buffer_load_dwordx4 v3, s[24:27], s96 offen offset:1024  lds
    s_add_u32 m0, s44, 2048
    s_nop 0
    buffer_load_dwordx4 v1, s[24:27], s97 offen  lds
    buffer_load_dwordx4 v3, s[24:27], s97 offen offset:1024  lds
    s_add_u32 m0, s44, 4096
    s_nop 0
    buffer_load_dwordx4 v1, s[24:27], s98 offen  lds
    buffer_load_dwordx4 v3, s[24:27], s98 offen offset:1024  lds
    s_add_u32 m0, s44, 6144
    s_nop 0
    buffer_load_dwordx4 v1, s[24:27], s99 offen  lds
    buffer_load_dwordx4 v3, s[24:27], s99 offen offset:1024  lds
    v_dot2_f32_bf16 v14, v160, v160, 0
    v_dot2_f32_bf16 v8, v161, v161, 0
    v_dot2_f32_bf16 v9, v162, v162, 0
    v_dot2_f32_bf16 v14, v163, v163, v14
    v_dot2_f32_bf16 v8, v164, v164, v8
    v_dot2_f32_bf16 v9, v165, v165, v9
    v_dot2_f32_bf16 v14, v166, v166, v14
    v_mfma_f32_4x4x4_16b_bf16 v[16:19], v[12:13], v[160:161], 0
    v_mfma_f32_4x4x4_16b_bf16 v[20:23], v[12:13], v[162:163], 0
    v_add_f32 v8, v8, v9
    v_add_f32 v14, v14, v8
    v_mov_b32 v15, v14
    v_mfma_f32_4x4x4_16b_bf16 v[24:27], v[12:13], v[164:165], 0
    v_mfma_f32_4x4x4_16b_bf16 v[28:31], v[12:13], v[166:167], 0
    v_permlane32_swap_b32 v14, v15
    v_add_f32 v14, v14, v15
    v_sqrt_f32 v14, v14
    s_nop 0
    v_add_f32 v14, 0x358637bd, v14
    v_rcp_f32 v14, v14
    s_nop 0
    v_mul_f32 v14, v11, v14
    v_pk_mul_f32 v[16:17], v[16:17], v[14:15] op_sel_hi:[1,0]
    v_pk_mul_f32 v[18:19], v[18:19], v[14:15] op_sel_hi:[1,0]
    v_pk_mul_f32 v[20:21], v[20:21], v[14:15] op_sel_hi:[1,0]
    v_pk_mul_f32 v[22:23], v[22:23], v[14:15] op_sel_hi:[1,0]
    v_pk_mul_f32 v[24:25], v[24:25], v[14:15] op_sel_hi:[1,0]
    v_pk_mul_f32 v[26:27], v[26:27], v[14:15] op_sel_hi:[1,0]
    v_pk_mul_f32 v[28:29], v[28:29], v[14:15] op_sel_hi:[1,0]
    v_cvt_pk_bf16_f32 v160, v16, v17
    v_cvt_pk_bf16_f32 v161, v18, v19
    v_cvt_pk_bf16_f32 v162, v20, v21
    v_cvt_pk_bf16_f32 v163, v22, v23
    v_cvt_pk_bf16_f32 v164, v24, v25
    v_cvt_pk_bf16_f32 v165, v26, v27
    v_cvt_pk_bf16_f32 v166, v28, v29
    ds_write_b128 v7, v[160:163] offset:8192
    ds_write_b128 v7, v[164:167] offset:9216
    v_dot2_f32_bf16 v14, v32, v32, 0
    v_dot2_f32_bf16 v15, v40, v40, 0
    v_dot2_f32_bf16 v8, v33, v33, 0
    v_dot2_f32_bf16 v9, v41, v41, 0
    v_dot2_f32_bf16 v14, v34, v34, v14
    v_dot2_f32_bf16 v15, v42, v42, v15
    v_dot2_f32_bf16 v8, v35, v35, v8
    v_dot2_f32_bf16 v9, v43, v43, v9
    v_dot2_f32_bf16 v14, v36, v36, v14
    v_dot2_f32_bf16 v15, v44, v44, v15
    v_dot2_f32_bf16 v8, v37, v37, v8
    v_dot2_f32_bf16 v9, v45, v45, v9
    v_dot2_f32_bf16 v14, v38, v38, v14
    v_dot2_f32_bf16 v15, v46, v46, v15
    v_mfma_f32_4x4x4_16b_bf16 v[16:19], v[12:13], v[32:33], 0
    v_mfma_f32_4x4x4_16b_bf16 v[20:23], v[12:13], v[34:35], 0
    v_add_f32 v14, v14, v8
    v_add_f32 v15, v15, v9
    v_mfma_f32_4x4x4_16b_bf16 v[24:27], v[12:13], v[36:37], 0
    v_mfma_f32_4x4x4_16b_bf16 v[28:31], v[12:13], v[38:39], 0
    v_permlane32_swap_b32 v14, v15
    v_add_f32 v14, v14, v15
    v_sqrt_f32 v14, v14
    v_mfma_f32_4x4x4_16b_bf16 v[208:211], v[12:13], v[40:41], 0
    v_add_f32 v14, 0x358637bd, v14
    v_rcp_f32 v14, v14
    v_mfma_f32_4x4x4_16b_bf16 v[212:215], v[12:13], v[42:43], 0
    v_mov_b32 v15, v14
    v_mfma_f32_4x4x4_16b_bf16 v[216:219], v[12:13], v[44:45], 0
    v_mfma_f32_4x4x4_16b_bf16 v[220:223], v[12:13], v[46:47], 0
    v_permlane32_swap_b32 v14, v15
    v_pk_mul_f32 v[16:17], v[16:17], v[14:15] op_sel_hi:[1,0]
    v_pk_mul_f32 v[18:19], v[18:19], v[14:15] op_sel_hi:[1,0]
    v_pk_mul_f32 v[20:21], v[20:21], v[14:15] op_sel_hi:[1,0]
    v_pk_mul_f32 v[22:23], v[22:23], v[14:15] op_sel_hi:[1,0]
    v_pk_mul_f32 v[24:25], v[24:25], v[14:15] op_sel_hi:[1,0]
    v_pk_mul_f32 v[26:27], v[26:27], v[14:15] op_sel_hi:[1,0]
    v_pk_mul_f32 v[28:29], v[28:29], v[14:15] op_sel_hi:[1,0]
    v_pk_mul_f32 v[208:209], v[208:209], v[14:15] op_sel:[0,1]
    v_pk_mul_f32 v[210:211], v[210:211], v[14:15] op_sel:[0,1]
    v_pk_mul_f32 v[212:213], v[212:213], v[14:15] op_sel:[0,1]
    v_pk_mul_f32 v[214:215], v[214:215], v[14:15] op_sel:[0,1]
    v_pk_mul_f32 v[216:217], v[216:217], v[14:15] op_sel:[0,1]
    v_pk_mul_f32 v[218:219], v[218:219], v[14:15] op_sel:[0,1]
    v_pk_mul_f32 v[220:221], v[220:221], v[14:15] op_sel:[0,1]
    v_cvt_pk_bf16_f32 v32, v16, v17
    v_cvt_pk_bf16_f32 v33, v18, v19
    v_cvt_pk_bf16_f32 v34, v20, v21
    v_cvt_pk_bf16_f32 v35, v22, v23
    v_cvt_pk_bf16_f32 v36, v24, v25
    v_cvt_pk_bf16_f32 v37, v26, v27
    v_cvt_pk_bf16_f32 v38, v28, v29
    v_cvt_pk_bf16_f32 v40, v208, v209
    v_cvt_pk_bf16_f32 v41, v210, v211
    v_cvt_pk_bf16_f32 v42, v212, v213
    v_cvt_pk_bf16_f32 v43, v214, v215
    v_cvt_pk_bf16_f32 v44, v216, v217
    v_cvt_pk_bf16_f32 v45, v218, v219
    v_cvt_pk_bf16_f32 v46, v220, v221
    v_dot2_f32_bf16 v14, v48, v48, 0
    v_dot2_f32_bf16 v15, v56, v56, 0
    v_dot2_f32_bf16 v8, v49, v49, 0
    v_dot2_f32_bf16 v9, v57, v57, 0
    v_dot2_f32_bf16 v14, v50, v50, v14
    v_dot2_f32_bf16 v15, v58, v58, v15
    v_dot2_f32_bf16 v8, v51, v51, v8
    v_dot2_f32_bf16 v9, v59, v59, v9
    v_dot2_f32_bf16 v14, v52, v52, v14
    v_dot2_f32_bf16 v15, v60, v60, v15
    v_dot2_f32_bf16 v8, v53, v53, v8
    v_dot2_f32_bf16 v9, v61, v61, v9
    v_dot2_f32_bf16 v14, v54, v54, v14
    v_dot2_f32_bf16 v15, v62, v62, v15
    v_mfma_f32_4x4x4_16b_bf16 v[16:19], v[12:13], v[48:49], 0
    v_mfma_f32_4x4x4_16b_bf16 v[20:23], v[12:13], v[50:51], 0
    v_add_f32 v14, v14, v8
    v_add_f32 v15, v15, v9
    v_mfma_f32_4x4x4_16b_bf16 v[24:27], v[12:13], v[52:53], 0
    v_mfma_f32_4x4x4_16b_bf16 v[28:31], v[12:13], v[54:55], 0
    v_permlane32_swap_b32 v14, v15
    v_add_f32 v14, v14, v15
    v_sqrt_f32 v14, v14
    v_mfma_f32_4x4x4_16b_bf16 v[208:211], v[12:13], v[56:57], 0
    v_add_f32 v14, 0x358637bd, v14
    v_rcp_f32 v14, v14
    v_mfma_f32_4x4x4_16b_bf16 v[212:215], v[12:13], v[58:59], 0
    v_mov_b32 v15, v14
    v_mfma_f32_4x4x4_16b_bf16 v[216:219], v[12:13], v[60:61], 0
    v_mfma_f32_4x4x4_16b_bf16 v[220:223], v[12:13], v[62:63], 0
    v_permlane32_swap_b32 v14, v15
    v_pk_mul_f32 v[16:17], v[16:17], v[14:15] op_sel_hi:[1,0]
    v_pk_mul_f32 v[18:19], v[18:19], v[14:15] op_sel_hi:[1,0]
    v_pk_mul_f32 v[20:21], v[20:21], v[14:15] op_sel_hi:[1,0]
    v_pk_mul_f32 v[22:23], v[22:23], v[14:15] op_sel_hi:[1,0]
    v_pk_mul_f32 v[24:25], v[24:25], v[14:15] op_sel_hi:[1,0]
    v_pk_mul_f32 v[26:27], v[26:27], v[14:15] op_sel_hi:[1,0]
    v_pk_mul_f32 v[28:29], v[28:29], v[14:15] op_sel_hi:[1,0]
    v_pk_mul_f32 v[208:209], v[208:209], v[14:15] op_sel:[0,1]
    v_pk_mul_f32 v[210:211], v[210:211], v[14:15] op_sel:[0,1]
    v_pk_mul_f32 v[212:213], v[212:213], v[14:15] op_sel:[0,1]
    v_pk_mul_f32 v[214:215], v[214:215], v[14:15] op_sel:[0,1]
    v_pk_mul_f32 v[216:217], v[216:217], v[14:15] op_sel:[0,1]
    v_pk_mul_f32 v[218:219], v[218:219], v[14:15] op_sel:[0,1]
    v_pk_mul_f32 v[220:221], v[220:221], v[14:15] op_sel:[0,1]
    v_cvt_pk_bf16_f32 v48, v16, v17
    v_cvt_pk_bf16_f32 v49, v18, v19
    v_cvt_pk_bf16_f32 v50, v20, v21
    v_cvt_pk_bf16_f32 v51, v22, v23
    v_cvt_pk_bf16_f32 v52, v24, v25
    v_cvt_pk_bf16_f32 v53, v26, v27
    v_cvt_pk_bf16_f32 v54, v28, v29
    v_cvt_pk_bf16_f32 v56, v208, v209
    v_cvt_pk_bf16_f32 v57, v210, v211
    v_cvt_pk_bf16_f32 v58, v212, v213
    v_cvt_pk_bf16_f32 v59, v214, v215
    v_cvt_pk_bf16_f32 v60, v216, v217
    v_cvt_pk_bf16_f32 v61, v218, v219
    v_cvt_pk_bf16_f32 v62, v220, v221
    v_dot2_f32_bf16 v14, v64, v64, 0
    v_dot2_f32_bf16 v15, v72, v72, 0
    v_dot2_f32_bf16 v8, v65, v65, 0
    v_dot2_f32_bf16 v9, v73, v73, 0
    v_dot2_f32_bf16 v14, v66, v66, v14
    v_dot2_f32_bf16 v15, v74, v74, v15
    v_dot2_f32_bf16 v8, v67, v67, v8
    v_dot2_f32_bf16 v9, v75, v75, v9
    v_dot2_f32_bf16 v14, v68, v68, v14
    v_dot2_f32_bf16 v15, v76, v76, v15
    v_dot2_f32_bf16 v8, v69, v69, v8
    v_dot2_f32_bf16 v9, v77, v77, v9
    v_dot2_f32_bf16 v14, v70, v70, v14
    v_dot2_f32_bf16 v15, v78, v78, v15
    v_mfma_f32_4x4x4_16b_bf16 v[16:19], v[12:13], v[64:65], 0
    v_mfma_f32_4x4x4_16b_bf16 v[20:23], v[12:13], v[66:67], 0
    v_add_f32 v14, v14, v8
    v_add_f32 v15, v15, v9
    v_mfma_f32_4x4x4_16b_bf16 v[24:27], v[12:13], v[68:69], 0
    v_mfma_f32_4x4x4_16b_bf16 v[28:31], v[12:13], v[70:71], 0
    v_permlane32_swap_b32 v14, v15
    v_add_f32 v14, v14, v15
    v_sqrt_f32 v14, v14
    v_mfma_f32_4x4x4_16b_bf16 v[208:211], v[12:13], v[72:73], 0
    v_add_f32 v14, 0x358637bd, v14
    v_rcp_f32 v14, v14
    v_mfma_f32_4x4x4_16b_bf16 v[212:215], v[12:13], v[74:75], 0
    v_mov_b32 v15, v14
    v_mfma_f32_4x4x4_16b_bf16 v[216:219], v[12:13], v[76:77], 0
    v_mfma_f32_4x4x4_16b_bf16 v[220:223], v[12:13], v[78:79], 0
    v_permlane32_swap_b32 v14, v15
    v_pk_mul_f32 v[16:17], v[16:17], v[14:15] op_sel_hi:[1,0]
    v_pk_mul_f32 v[18:19], v[18:19], v[14:15] op_sel_hi:[1,0]
    v_pk_mul_f32 v[20:21], v[20:21], v[14:15] op_sel_hi:[1,0]
    v_pk_mul_f32 v[22:23], v[22:23], v[14:15] op_sel_hi:[1,0]
    v_pk_mul_f32 v[24:25], v[24:25], v[14:15] op_sel_hi:[1,0]
    v_pk_mul_f32 v[26:27], v[26:27], v[14:15] op_sel_hi:[1,0]
    v_pk_mul_f32 v[28:29], v[28:29], v[14:15] op_sel_hi:[1,0]
    v_pk_mul_f32 v[208:209], v[208:209], v[14:15] op_sel:[0,1]
    v_pk_mul_f32 v[210:211], v[210:211], v[14:15] op_sel:[0,1]
    v_pk_mul_f32 v[212:213], v[212:213], v[14:15] op_sel:[0,1]
    v_pk_mul_f32 v[214:215], v[214:215], v[14:15] op_sel:[0,1]
    v_pk_mul_f32 v[216:217], v[216:217], v[14:15] op_sel:[0,1]
    v_pk_mul_f32 v[218:219], v[218:219], v[14:15] op_sel:[0,1]
    v_pk_mul_f32 v[220:221], v[220:221], v[14:15] op_sel:[0,1]
    v_cvt_pk_bf16_f32 v64, v16, v17
    v_cvt_pk_bf16_f32 v65, v18, v19
    v_cvt_pk_bf16_f32 v66, v20, v21
    v_cvt_pk_bf16_f32 v67, v22, v23
    v_cvt_pk_bf16_f32 v68, v24, v25
    v_cvt_pk_bf16_f32 v69, v26, v27
    v_cvt_pk_bf16_f32 v70, v28, v29
    v_cvt_pk_bf16_f32 v72, v208, v209
    v_cvt_pk_bf16_f32 v73, v210, v211
    v_cvt_pk_bf16_f32 v74, v212, v213
    v_cvt_pk_bf16_f32 v75, v214, v215
    v_cvt_pk_bf16_f32 v76, v216, v217
    v_cvt_pk_bf16_f32 v77, v218, v219
    v_cvt_pk_bf16_f32 v78, v220, v221
    v_dot2_f32_bf16 v14, v80, v80, 0
    v_dot2_f32_bf16 v15, v88, v88, 0
    v_dot2_f32_bf16 v8, v81, v81, 0
    v_dot2_f32_bf16 v9, v89, v89, 0
    v_dot2_f32_bf16 v14, v82, v82, v14
    v_dot2_f32_bf16 v15, v90, v90, v15
    v_dot2_f32_bf16 v8, v83, v83, v8
    v_dot2_f32_bf16 v9, v91, v91, v9
    v_dot2_f32_bf16 v14, v84, v84, v14
    v_dot2_f32_bf16 v15, v92, v92, v15
    v_dot2_f32_bf16 v8, v85, v85, v8
    v_dot2_f32_bf16 v9, v93, v93, v9
    v_dot2_f32_bf16 v14, v86, v86, v14
    v_dot2_f32_bf16 v15, v94, v94, v15
    v_mfma_f32_4x4x4_16b_bf16 v[16:19], v[12:13], v[80:81], 0
    v_mfma_f32_4x4x4_16b_bf16 v[20:23], v[12:13], v[82:83], 0
    v_add_f32 v14, v14, v8
    v_add_f32 v15, v15, v9
    v_mfma_f32_4x4x4_16b_bf16 v[24:27], v[12:13], v[84:85], 0
    v_mfma_f32_4x4x4_16b_bf16 v[28:31], v[12:13], v[86:87], 0
    v_permlane32_swap_b32 v14, v15
    v_add_f32 v14, v14, v15
    v_sqrt_f32 v14, v14
    v_mfma_f32_4x4x4_16b_bf16 v[208:211], v[12:13], v[88:89], 0
    v_add_f32 v14, 0x358637bd, v14
    v_rcp_f32 v14, v14
    v_mfma_f32_4x4x4_16b_bf16 v[212:215], v[12:13], v[90:91], 0
    v_mov_b32 v15, v14
    v_mfma_f32_4x4x4_16b_bf16 v[216:219], v[12:13], v[92:93], 0
    v_mfma_f32_4x4x4_16b_bf16 v[220:223], v[12:13], v[94:95], 0
    v_permlane32_swap_b32 v14, v15
    v_pk_mul_f32 v[16:17], v[16:17], v[14:15] op_sel_hi:[1,0]
    v_pk_mul_f32 v[18:19], v[18:19], v[14:15] op_sel_hi:[1,0]
    v_pk_mul_f32 v[20:21], v[20:21], v[14:15] op_sel_hi:[1,0]
    v_pk_mul_f32 v[22:23], v[22:23], v[14:15] op_sel_hi:[1,0]
    v_pk_mul_f32 v[24:25], v[24:25], v[14:15] op_sel_hi:[1,0]
    v_pk_mul_f32 v[26:27], v[26:27], v[14:15] op_sel_hi:[1,0]
    v_pk_mul_f32 v[28:29], v[28:29], v[14:15] op_sel_hi:[1,0]
    v_pk_mul_f32 v[208:209], v[208:209], v[14:15] op_sel:[0,1]
    v_pk_mul_f32 v[210:211], v[210:211], v[14:15] op_sel:[0,1]
    v_pk_mul_f32 v[212:213], v[212:213], v[14:15] op_sel:[0,1]
    v_pk_mul_f32 v[214:215], v[214:215], v[14:15] op_sel:[0,1]
    v_pk_mul_f32 v[216:217], v[216:217], v[14:15] op_sel:[0,1]
    v_pk_mul_f32 v[218:219], v[218:219], v[14:15] op_sel:[0,1]
    v_pk_mul_f32 v[220:221], v[220:221], v[14:15] op_sel:[0,1]
    v_cvt_pk_bf16_f32 v80, v16, v17
    v_cvt_pk_bf16_f32 v81, v18, v19
    v_cvt_pk_bf16_f32 v82, v20, v21
    v_cvt_pk_bf16_f32 v83, v22, v23
    v_cvt_pk_bf16_f32 v84, v24, v25
    v_cvt_pk_bf16_f32 v85, v26, v27
    v_cvt_pk_bf16_f32 v86, v28, v29
    v_cvt_pk_bf16_f32 v88, v208, v209
    v_cvt_pk_bf16_f32 v89, v210, v211
    v_cvt_pk_bf16_f32 v90, v212, v213
    v_cvt_pk_bf16_f32 v91, v214, v215
    v_cvt_pk_bf16_f32 v92, v216, v217
    v_cvt_pk_bf16_f32 v93, v218, v219
    v_cvt_pk_bf16_f32 v94, v220, v221
    s_waitcnt vmcnt(0)
    ds_read_b64_tr_b16 v[128:129], v4 offset:0
    ds_read_b64_tr_b16 v[130:131], v4 offset:224
    ds_read_b64_tr_b16 v[132:133], v4 offset:896
    ds_read_b64_tr_b16 v[134:135], v4 offset:1120
    ds_read_b64_tr_b16 v[136:137], v4 offset:2048
    ds_read_b64_tr_b16 v[138:139], v4 offset:2272
    ds_read_b64_tr_b16 v[140:141], v4 offset:2944
    ds_read_b64_tr_b16 v[142:143], v4 offset:3168
    ds_read_b64_tr_b16 v[144:145], v4 offset:4096
    ds_read_b64_tr_b16 v[146:147], v4 offset:4320
    ds_read_b64_tr_b16 v[148:149], v4 offset:4992
    ds_read_b64_tr_b16 v[150:151], v4 offset:5216
    ds_read_b64_tr_b16 v[152:153], v4 offset:6144
    ds_read_b64_tr_b16 v[154:155], v4 offset:6368
    ds_read_b64_tr_b16 v[156:157], v4 offset:7040
    ds_read_b64_tr_b16 v[158:159], v4 offset:7264
    v_and_b32 v16, 31, v0
    v_lshlrev_b32 v16, 2, v16
    v_add_u32 v16, 113920, v16
    s_lshl_b32 s55, s3, 7
    v_add_u32 v17, s55, v16
    v_mov_b32 v14, 0xff800000
    ds_write_b32 v17, v14
    s_waitcnt lgkmcnt(0)
    ds_write_b128 v7, v[176:179] offset:0
    ds_write_b128 v7, v[176:179] offset:1024
    ds_write_b128 v7, v[176:179] offset:2048
    ds_write_b128 v7, v[176:179] offset:3072
    s_waitcnt lgkmcnt(0)
    s_barrier
    s_mov_b32 s53, 0
    v_mov_b32 v9, v1
    v_mov_b32 v17, v16
L_slow1:
    ds_read_b128 v[160:163], v9 offset:8192
    ds_read_b128 v[164:167], v9 offset:9216
    v_mov_b32 v14, 0xff800000
    s_waitcnt lgkmcnt(0)
    v_mfma_f32_32x32x16_bf16 v[208:223], v[36:39], v[164:167], 0
    v_mfma_f32_32x32x16_bf16 v[208:223], v[32:35], v[160:163], v[208:223]
    s_nop 11
    v_max3_f32 v14, v208, v209, v14
    v_max3_f32 v14, v210, v211, v14
    v_max3_f32 v14, v212, v213, v14
    v_max3_f32 v14, v214, v215, v14
    v_max3_f32 v14, v216, v217, v14
    v_max3_f32 v14, v218, v219, v14
    v_max3_f32 v14, v220, v221, v14
    v_max3_f32 v14, v222, v223, v14
    v_mfma_f32_32x32x16_bf16 v[208:223], v[44:47], v[164:167], 0
    v_mfma_f32_32x32x16_bf16 v[208:223], v[40:43], v[160:163], v[208:223]
    s_nop 11
    v_max3_f32 v14, v208, v209, v14
    v_max3_f32 v14, v210, v211, v14
    v_max3_f32 v14, v212, v213, v14
    v_max3_f32 v14, v214, v215, v14
    v_max3_f32 v14, v216, v217, v14
    v_max3_f32 v14, v218, v219, v14
    v_max3_f32 v14, v220, v221, v14
    v_max3_f32 v14, v222, v223, v14
    v_mfma_f32_32x32x16_bf16 v[208:223], v[52:55], v[164:167], 0
    v_mfma_f32_32x32x16_bf16 v[208:223], v[48:51], v[160:163], v[208:223]
    s_nop 11
    v_max3_f32 v14, v208, v209, v14
    v_max3_f32 v14, v210, v211, v14
    v_max3_f32 v14, v212, v213, v14
    v_max3_f32 v14, v214, v215, v14
    v_max3_f32 v14, v216, v217, v14
    v_max3_f32 v14, v218, v219, v14
    v_max3_f32 v14, v220, v221, v14
    v_max3_f32 v14, v222, v223, v14
    v_mfma_f32_32x32x16_bf16 v[208:223], v[60:63], v[164:167], 0
    v_mfma_f32_32x32x16_bf16 v[208:223], v[56:59], v[160:163], v[208:223]
    s_nop 11
    v_max3_f32 v14, v208, v209, v14
    v_max3_f32 v14, v210, v211, v14
    v_max3_f32 v14, v212, v213, v14
    v_max3_f32 v14, v214, v215, v14
    v_max3_f32 v14, v216, v217, v14
    v_max3_f32 v14, v218, v219, v14
    v_max3_f32 v14, v220, v221, v14
    v_max3_f32 v14, v222, v223, v14
    v_mfma_f32_32x32x16_bf16 v[208:223], v[68:71], v[164:167], 0
    v_mfma_f32_32x32x16_bf16 v[208:223], v[64:67], v[160:163], v[208:223]
    s_nop 11
    v_max3_f32 v14, v208, v209, v14
    v_max3_f32 v14, v210, v211, v14
    v_max3_f32 v14, v212, v213, v14
    v_max3_f32 v14, v214, v215, v14
    v_max3_f32 v14, v216, v217, v14
    v_max3_f32 v14, v218, v219, v14
    v_max3_f32 v14, v220, v221, v14
    v_max3_f32 v14, v222, v223, v14
    v_mfma_f32_32x32x16_bf16 v[208:223], v[76:79], v[164:167], 0
    v_mfma_f32_32x32x16_bf16 v[208:223], v[72:75], v[160:163], v[208:223]
    s_nop 11
    v_max3_f32 v14, v208, v209, v14
    v_max3_f32 v14, v210, v211, v14
    v_max3_f32 v14, v212, v213, v14
    v_max3_f32 v14, v214, v215, v14
    v_max3_f32 v14, v216, v217, v14
    v_max3_f32 v14, v218, v219, v14
    v_max3_f32 v14, v220, v221, v14
    v_max3_f32 v14, v222, v223, v14
    v_mfma_f32_32x32x16_bf16 v[208:223], v[84:87], v[164:167], 0
    v_mfma_f32_32x32x16_bf16 v[208:223], v[80:83], v[160:163], v[208:223]
    s_nop 11
    v_max3_f32 v14, v208, v209, v14
    v_max3_f32 v14, v210, v211, v14
    v_max3_f32 v14, v212, v213, v14
    v_max3_f32 v14, v214, v215, v14
    v_max3_f32 v14, v216, v217, v14
    v_max3_f32 v14, v218, v219, v14
    v_max3_f32 v14, v220, v221, v14
    v_max3_f32 v14, v222, v223, v14
    v_mfma_f32_32x32x16_bf16 v[208:223], v[92:95], v[164:167], 0
    v_mfma_f32_32x32x16_bf16 v[208:223], v[88:91], v[160:163], v[208:223]
    s_nop 11
    v_max3_f32 v14, v208, v209, v14
    v_max3_f32 v14, v210, v211, v14
    v_max3_f32 v14, v212, v213, v14
    v_max3_f32 v14, v214, v215, v14
    v_max3_f32 v14, v216, v217, v14
    v_max3_f32 v14, v218, v219, v14
    v_max3_f32 v14, v220, v221, v14
    v_max3_f32 v14, v222, v223, v14
    ds_max_f32 v17, v14
    v_add_u32 v9, 13312, v9
    v_add_u32 v17, 128, v17
    s_add_u32 s53, s53, 1
    s_cmp_lt_u32 s53, 8
    s_waitcnt lgkmcnt(0)
    s_cbranch_scc1 L_slow1
    s_barrier
    s_mov_b32 s53, 0
    v_mov_b32 v9, v1
L_slow2:
    ds_read_b128 v[160:163], v9 offset:8192
    ds_read_b128 v[164:167], v9 offset:9216
    ds_read_b32 v14, v16
    v_mov_b32 v176, 0
    v_mov_b32 v177, 0
    v_mov_b32 v178, 0
    v_mov_b32 v179, 0
    v_mov_b32 v180, 0
    v_mov_b32 v181, 0
    v_mov_b32 v182, 0
    v_mov_b32 v183, 0
    v_mov_b32 v184, 0
    v_mov_b32 v185, 0
    v_mov_b32 v186, 0
    v_mov_b32 v187, 0
    v_mov_b32 v188, 0
    v_mov_b32 v189, 0
    v_mov_b32 v190, 0
    v_mov_b32 v191, 0
    s_waitcnt lgkmcnt(0)
    v_mfma_f32_32x32x16_bf16 v[208:223], v[36:39], v[164:167], 0
    v_mfma_f32_32x32x16_bf16 v[208:223], v[32:35], v[160:163], v[208:223]
    s_nop 11
    v_sub_f32 v240, v208, v14
    v_sub_f32 v241, v209, v14
    v_sub_f32 v242, v210, v14
    v_sub_f32 v243, v211, v14
    v_sub_f32 v244, v212, v14
    v_sub_f32 v245, v213, v14
    v_sub_f32 v246, v214, v14
    v_sub_f32 v247, v215, v14
    v_sub_f32 v248, v216, v14
    v_sub_f32 v249, v217, v14
    v_sub_f32 v250, v218, v14
    v_sub_f32 v251, v219, v14
    v_sub_f32 v252, v220, v14
    v_sub_f32 v253, v221, v14
    v_sub_f32 v254, v222, v14
    v_sub_f32 v255, v223, v14
    v_exp_f32 v240, v240
    v_exp_f32 v241, v241
    v_exp_f32 v242, v242
    v_exp_f32 v243, v243
    v_exp_f32 v244, v244
    v_exp_f32 v245, v245
    v_exp_f32 v246, v246
    v_exp_f32 v247, v247
    v_exp_f32 v248, v248
    v_exp_f32 v249, v249
    v_exp_f32 v250, v250
    v_exp_f32 v251, v251
    v_exp_f32 v252, v252
    v_exp_f32 v253, v253
    v_exp_f32 v254, v254
    v_exp_f32 v255, v255
    v_smfmac_f32_32x32x32_bf16 v[176:191], v[96:99], v[240:247], v6
    s_nop 0
    v_smfmac_f32_32x32x32_bf16 v[176:191], v[100:103], v[248:255], v6
    v_mfma_f32_32x32x16_bf16 v[208:223], v[44:47], v[164:167], 0
    v_mfma_f32_32x32x16_bf16 v[208:223], v[40:43], v[160:163], v[208:223]
    s_nop 11
    v_sub_f32 v240, v208, v14
    v_sub_f32 v241, v209, v14
    v_sub_f32 v242, v210, v14
    v_sub_f32 v243, v211, v14
    v_sub_f32 v244, v212, v14
    v_sub_f32 v245, v213, v14
    v_sub_f32 v246, v214, v14
    v_sub_f32 v247, v215, v14
    v_sub_f32 v248, v216, v14
    v_sub_f32 v249, v217, v14
    v_sub_f32 v250, v218, v14
    v_sub_f32 v251, v219, v14
    v_sub_f32 v252, v220, v14
    v_sub_f32 v253, v221, v14
    v_sub_f32 v254, v222, v14
    v_sub_f32 v255, v223, v14
    v_exp_f32 v240, v240
    v_exp_f32 v241, v241
    v_exp_f32 v242, v242
    v_exp_f32 v243, v243
    v_exp_f32 v244, v244
    v_exp_f32 v245, v245
    v_exp_f32 v246, v246
    v_exp_f32 v247, v247
    v_exp_f32 v248, v248
    v_exp_f32 v249, v249
    v_exp_f32 v250, v250
    v_exp_f32 v251, v251
    v_exp_f32 v252, v252
    v_exp_f32 v253, v253
    v_exp_f32 v254, v254
    v_exp_f32 v255, v255
    v_smfmac_f32_32x32x32_bf16 v[176:191], v[104:107], v[240:247], v6
    s_nop 0
    v_smfmac_f32_32x32x32_bf16 v[176:191], v[108:111], v[248:255], v6
    v_mfma_f32_32x32x16_bf16 v[208:223], v[52:55], v[164:167], 0
    v_mfma_f32_32x32x16_bf16 v[208:223], v[48:51], v[160:163], v[208:223]
    s_nop 11
    v_sub_f32 v240, v208, v14
    v_sub_f32 v241, v209, v14
    v_sub_f32 v242, v210, v14
    v_sub_f32 v243, v211, v14
    v_sub_f32 v244, v212, v14
    v_sub_f32 v245, v213, v14
    v_sub_f32 v246, v214, v14
    v_sub_f32 v247, v215, v14
    v_sub_f32 v248, v216, v14
    v_sub_f32 v249, v217, v14
    v_sub_f32 v250, v218, v14
    v_sub_f32 v251, v219, v14
    v_sub_f32 v252, v220, v14
    v_sub_f32 v253, v221, v14
    v_sub_f32 v254, v222, v14
    v_sub_f32 v255, v223, v14
    v_exp_f32 v240, v240
    v_exp_f32 v241, v241
    v_exp_f32 v242, v242
    v_exp_f32 v243, v243
    v_exp_f32 v244, v244
    v_exp_f32 v245, v245
    v_exp_f32 v246, v246
    v_exp_f32 v247, v247
    v_exp_f32 v248, v248
    v_exp_f32 v249, v249
    v_exp_f32 v250, v250
    v_exp_f32 v251, v251
    v_exp_f32 v252, v252
    v_exp_f32 v253, v253
    v_exp_f32 v254, v254
    v_exp_f32 v255, v255
    v_smfmac_f32_32x32x32_bf16 v[176:191], v[112:115], v[240:247], v6
    s_nop 0
    v_smfmac_f32_32x32x32_bf16 v[176:191], v[116:119], v[248:255], v6
    v_mfma_f32_32x32x16_bf16 v[208:223], v[60:63], v[164:167], 0
    v_mfma_f32_32x32x16_bf16 v[208:223], v[56:59], v[160:163], v[208:223]
    s_nop 11
    v_sub_f32 v240, v208, v14
    v_sub_f32 v241, v209, v14
    v_sub_f32 v242, v210, v14
    v_sub_f32 v243, v211, v14
    v_sub_f32 v244, v212, v14
    v_sub_f32 v245, v213, v14
    v_sub_f32 v246, v214, v14
    v_sub_f32 v247, v215, v14
    v_sub_f32 v248, v216, v14
    v_sub_f32 v249, v217, v14
    v_sub_f32 v250, v218, v14
    v_sub_f32 v251, v219, v14
    v_sub_f32 v252, v220, v14
    v_sub_f32 v253, v221, v14
    v_sub_f32 v254, v222, v14
    v_sub_f32 v255, v223, v14
    v_exp_f32 v240, v240
    v_exp_f32 v241, v241
    v_exp_f32 v242, v242
    v_exp_f32 v243, v243
    v_exp_f32 v244, v244
    v_exp_f32 v245, v245
    v_exp_f32 v246, v246
    v_exp_f32 v247, v247
    v_exp_f32 v248, v248
    v_exp_f32 v249, v249
    v_exp_f32 v250, v250
    v_exp_f32 v251, v251
    v_exp_f32 v252, v252
    v_exp_f32 v253, v253
    v_exp_f32 v254, v254
    v_exp_f32 v255, v255
    v_smfmac_f32_32x32x32_bf16 v[176:191], v[120:123], v[240:247], v6
    s_nop 0
    v_smfmac_f32_32x32x32_bf16 v[176:191], v[124:127], v[248:255], v6
    v_mfma_f32_32x32x16_bf16 v[208:223], v[68:71], v[164:167], 0
    v_mfma_f32_32x32x16_bf16 v[208:223], v[64:67], v[160:163], v[208:223]
    s_nop 11
    v_sub_f32 v240, v208, v14
    v_sub_f32 v241, v209, v14
    v_sub_f32 v242, v210, v14
    v_sub_f32 v243, v211, v14
    v_sub_f32 v244, v212, v14
    v_sub_f32 v245, v213, v14
    v_sub_f32 v246, v214, v14
    v_sub_f32 v247, v215, v14
    v_sub_f32 v248, v216, v14
    v_sub_f32 v249, v217, v14
    v_sub_f32 v250, v218, v14
    v_sub_f32 v251, v219, v14
    v_sub_f32 v252, v220, v14
    v_sub_f32 v253, v221, v14
    v_sub_f32 v254, v222, v14
    v_sub_f32 v255, v223, v14
    v_exp_f32 v240, v240
    v_exp_f32 v241, v241
    v_exp_f32 v242, v242
    v_exp_f32 v243, v243
    v_exp_f32 v244, v244
    v_exp_f32 v245, v245
    v_exp_f32 v246, v246
    v_exp_f32 v247, v247
    v_exp_f32 v248, v248
    v_exp_f32 v249, v249
    v_exp_f32 v250, v250
    v_exp_f32 v251, v251
    v_exp_f32 v252, v252
    v_exp_f32 v253, v253
    v_exp_f32 v254, v254
    v_exp_f32 v255, v255
    v_smfmac_f32_32x32x32_bf16 v[176:191], v[128:131], v[240:247], v6
    s_nop 0
    v_smfmac_f32_32x32x32_bf16 v[176:191], v[132:135], v[248:255], v6
    v_mfma_f32_32x32x16_bf16 v[208:223], v[76:79], v[164:167], 0
    v_mfma_f32_32x32x16_bf16 v[208:223], v[72:75], v[160:163], v[208:223]
    s_nop 11
    v_sub_f32 v240, v208, v14
    v_sub_f32 v241, v209, v14
    v_sub_f32 v242, v210, v14
    v_sub_f32 v243, v211, v14
    v_sub_f32 v244, v212, v14
    v_sub_f32 v245, v213, v14
    v_sub_f32 v246, v214, v14
    v_sub_f32 v247, v215, v14
    v_sub_f32 v248, v216, v14
    v_sub_f32 v249, v217, v14
    v_sub_f32 v250, v218, v14
    v_sub_f32 v251, v219, v14
    v_sub_f32 v252, v220, v14
    v_sub_f32 v253, v221, v14
    v_sub_f32 v254, v222, v14
    v_sub_f32 v255, v223, v14
    v_exp_f32 v240, v240
    v_exp_f32 v241, v241
    v_exp_f32 v242, v242
    v_exp_f32 v243, v243
    v_exp_f32 v244, v244
    v_exp_f32 v245, v245
    v_exp_f32 v246, v246
    v_exp_f32 v247, v247
    v_exp_f32 v248, v248
    v_exp_f32 v249, v249
    v_exp_f32 v250, v250
    v_exp_f32 v251, v251
    v_exp_f32 v252, v252
    v_exp_f32 v253, v253
    v_exp_f32 v254, v254
    v_exp_f32 v255, v255
    v_smfmac_f32_32x32x32_bf16 v[176:191], v[136:139], v[240:247], v6
    s_nop 0
    v_smfmac_f32_32x32x32_bf16 v[176:191], v[140:143], v[248:255], v6
    v_mfma_f32_32x32x16_bf16 v[208:223], v[84:87], v[164:167], 0
    v_mfma_f32_32x32x16_bf16 v[208:223], v[80:83], v[160:163], v[208:223]
    s_nop 11
    v_sub_f32 v240, v208, v14
    v_sub_f32 v241, v209, v14
    v_sub_f32 v242, v210, v14
    v_sub_f32 v243, v211, v14
    v_sub_f32 v244, v212, v14
    v_sub_f32 v245, v213, v14
    v_sub_f32 v246, v214, v14
    v_sub_f32 v247, v215, v14
    v_sub_f32 v248, v216, v14
    v_sub_f32 v249, v217, v14
    v_sub_f32 v250, v218, v14
    v_sub_f32 v251, v219, v14
    v_sub_f32 v252, v220, v14
    v_sub_f32 v253, v221, v14
    v_sub_f32 v254, v222, v14
    v_sub_f32 v255, v223, v14
    v_exp_f32 v240, v240
    v_exp_f32 v241, v241
    v_exp_f32 v242, v242
    v_exp_f32 v243, v243
    v_exp_f32 v244, v244
    v_exp_f32 v245, v245
    v_exp_f32 v246, v246
    v_exp_f32 v247, v247
    v_exp_f32 v248, v248
    v_exp_f32 v249, v249
    v_exp_f32 v250, v250
    v_exp_f32 v251, v251
    v_exp_f32 v252, v252
    v_exp_f32 v253, v253
    v_exp_f32 v254, v254
    v_exp_f32 v255, v255
    v_smfmac_f32_32x32x32_bf16 v[176:191], v[144:147], v[240:247], v6
    s_nop 0
    v_smfmac_f32_32x32x32_bf16 v[176:191], v[148:151], v[248:255], v6
    v_mfma_f32_32x32x16_bf16 v[208:223], v[92:95], v[164:167], 0
    v_mfma_f32_32x32x16_bf16 v[208:223], v[88:91], v[160:163], v[208:223]
    s_nop 11
    v_sub_f32 v240, v208, v14
    v_sub_f32 v241, v209, v14
    v_sub_f32 v242, v210, v14
    v_sub_f32 v243, v211, v14
    v_sub_f32 v244, v212, v14
    v_sub_f32 v245, v213, v14
    v_sub_f32 v246, v214, v14
    v_sub_f32 v247, v215, v14
    v_sub_f32 v248, v216, v14
    v_sub_f32 v249, v217, v14
    v_sub_f32 v250, v218, v14
    v_sub_f32 v251, v219, v14
    v_sub_f32 v252, v220, v14
    v_sub_f32 v253, v221, v14
    v_sub_f32 v254, v222, v14
    v_sub_f32 v255, v223, v14
    v_exp_f32 v240, v240
    v_exp_f32 v241, v241
    v_exp_f32 v242, v242
    v_exp_f32 v243, v243
    v_exp_f32 v244, v244
    v_exp_f32 v245, v245
    v_exp_f32 v246, v246
    v_exp_f32 v247, v247
    v_exp_f32 v248, v248
    v_exp_f32 v249, v249
    v_exp_f32 v250, v250
    v_exp_f32 v251, v251
    v_exp_f32 v252, v252
    v_exp_f32 v253, v253
    v_exp_f32 v254, v254
    v_exp_f32 v255, v255
    v_smfmac_f32_32x32x32_bf16 v[176:191], v[152:155], v[240:247], v6
    s_nop 0
    v_smfmac_f32_32x32x32_bf16 v[176:191], v[156:159], v[248:255], v6
    s_nop 11
    ds_add_f32 v9, v176 offset:0
    ds_add_f32 v9, v177 offset:4
    ds_add_f32 v9, v178 offset:8
    ds_add_f32 v9, v179 offset:12
    ds_add_f32 v9, v180 offset:1024
    ds_add_f32 v9, v181 offset:1028
    ds_add_f32 v9, v182 offset:1032
    ds_add_f32 v9, v183 offset:1036
    ds_add_f32 v9, v184 offset:2048
    ds_add_f32 v9, v185 offset:2052
    ds_add_f32 v9, v186 offset:2056
    ds_add_f32 v9, v187 offset:2060
    ds_add_f32 v9, v188 offset:3072
    ds_add_f32 v9, v189 offset:3076
    ds_add_f32 v9, v190 offset:3080
    ds_add_f32 v9, v191 offset:3084
    v_add_u32 v9, 13312, v9
    v_add_u32 v16, 128, v16
    s_add_u32 s53, s53, 1
    s_cmp_lt_u32 s53, 8
    s_waitcnt lgkmcnt(0)
    s_cbranch_scc1 L_slow2
    s_barrier
    v_mov_b32 v11, v7
    ds_read_b128 v[176:179], v7 offset:0
    ds_read_b128 v[180:183], v7 offset:1024
    ds_read_b128 v[184:187], v7 offset:2048
    ds_read_b128 v[188:191], v7 offset:3072
    s_waitcnt lgkmcnt(0)
    s_branch L_fin
.section .rodata,"a"
.p2align 6
.amdhsa_kernel standalone__qk_norm__prompt_kernel
  .amdhsa_next_free_vgpr 256
  .amdhsa_next_free_sgpr 102
  .amdhsa_accum_offset 256
  .amdhsa_group_segment_fixed_size 0
  .amdhsa_kernarg_size 56
  .amdhsa_user_sgpr_count 2
  .amdhsa_user_sgpr_kernarg_segment_ptr 1
  .amdhsa_system_sgpr_workgroup_id_x 1
.end_amdhsa_kernel
```
